```python
import torch

def _softmax(x, axis=-1):
    return torch.softmax(x, dim=axis)
def _gelu(x):
    return torch.nn.functional.gelu(x, approximate="tanh")
def _silu(x):
    return torch.nn.functional.silu(x)
def _sigmoid(x):
    return torch.sigmoid(x)
def _layernorm(x, axis=-1, eps=1e-5):
    m = x.mean(dim=axis, keepdim=True)
    v = x.var(dim=axis, keepdim=True, unbiased=False)
    return (x - m) / torch.sqrt(v + eps)
def _scatter_add(tgt, idx, src, axis=0):
    return tgt.clone().index_add_(axis, idx, src)
def _segment_sum(src, seg, n):
    out = torch.zeros((n,) + src.shape[1:], dtype=src.dtype)
    return out.index_add_(0, seg, src)
def _pad(x, pw):
    flat = tuple(v for pair in reversed(pw) for v in pair)
    return torch.nn.functional.pad(x, flat)

kernel_name = 'standalone__hybrid_graph_tf_nagphormer__graph'

def setup_inputs():

    _w = (lambda a: (lambda t: t.to(torch.bfloat16) if t.is_floating_point() else t)(torch.as_tensor(a)))
    N, deg, D = 50000, 16, 64
    E = N * deg
    src = (lambda lo, hi, *s: torch.randint(lo, hi, s))(0, N, E).to(torch.int64)
    dst = (lambda lo, hi, *s: torch.randint(lo, hi, s))(0, N, E).to(torch.int64)
    deg_cnt = torch.bincount(dst, minlength=N).to(float) + 1.0
    sc = 1.0 / D ** 0.5
    return {
        "x": _w((lambda *s: torch.randn(*s, dtype=torch.bfloat16) * 0.1)(N, D)),
        "src": _w(src),
        "dst": _w(dst),
        "deg_inv_sqrt": _w(1.0 / (lambda _x: torch.sqrt(torch.as_tensor(_x)))(deg_cnt)),
        "wq": _w((lambda *s: torch.randn(*s, dtype=torch.bfloat16) * 3.2)(D, D) * sc),
        "wk": _w((lambda *s: torch.randn(*s, dtype=torch.bfloat16) * 3.2)(D, D) * sc),
        "wv": _w((lambda *s: torch.randn(*s, dtype=torch.bfloat16) * 0.1)(D, D) * sc),
        "wo": _w((lambda *s: torch.randn(*s, dtype=torch.bfloat16) * 0.1)(D, D) * sc),
        "w_r": _w((lambda *s: torch.randn(*s, dtype=torch.bfloat16) * 0.1)(D)),
    }

def reference(x, src, dst, deg_inv_sqrt, wq, wk, wv, wo, w_r):
    N, D = x.shape[0], x.shape[1]
    K = 7
    h = x
    toks = [x]
    for _ in range(K):
        msg = h[src] * deg_inv_sqrt[src, None] * deg_inv_sqrt[dst, None]
        h = _segment_sum(msg, dst, N)
        toks.append(h)
    tok = torch.stack(toks, axis=1)
    t = _layernorm(tok, axis=-1)
    q   = torch.einsum('nkd,de->nke', t, wq)
    key = torch.einsum('nkd,de->nke', t, wk)
    v   = torch.einsum('nkd,de->nke', t, wv)
    scale = 1.0 / (D ** 0.5)
    attn = _softmax(torch.einsum('nkd,nld->nkl', q, key) * scale, axis=-1)
    o = torch.einsum('nkl,nld->nkd', attn, v)
    o = tok + torch.einsum('nkd,de->nke', o, wo)
    r = _layernorm(o, axis=-1)
    alpha = _softmax(torch.einsum('nkd,d->nk', r, w_r), axis=-1)
    return torch.einsum('nk,nkd->nd', alpha, o)
```

```asm
; @launch grid=(256,1,1) block=(512,1,1) lds=161024
.amdgcn_target "amdgcn-amd-amdhsa--gfx950"
.text
.globl standalone__hybrid_graph_tf_nagphormer__graph_kernel
.p2align 8
.type standalone__hybrid_graph_tf_nagphormer__graph_kernel,@function
standalone__hybrid_graph_tf_nagphormer__graph_kernel:
    s_cmp_ge_u32 s2, 256
    s_cbranch_scc1 K2_EXIT
    s_load_dwordx8 s[64:71], s[0:1], 0
    s_getpc_b64 s[80:81]
PF_BASE:
    v_lshrrev_b32 v8, 6, v0
    s_and_b32 s54, s2, 0xf8
    v_add_lshl_u32 v16, v8, s54, 7
    v_min_u32 v16, K2_CODE_END-PF_BASE-4, v16
    global_load_dword v107, v16, s[80:81]
    s_load_dwordx2 s[14:15], s[0:1], 88
    s_load_dwordx4 s[8:11], s[0:1], 72
    s_sub_u32 s94, s2, 6
    s_mul_i32 s54, s94, 12800
    v_lshlrev_b32 v12, 4, v0
    v_readfirstlane_b32 s3, v8
    v_mov_b32 v175, 0
    v_lshlrev_b32 v16, 2, v0
    v_add_u32 v16, 65536, v16
    ds_write_b32 v16, v175
    v_add_u32 v30, s54, v12
    v_cmp_gt_u32 vcc, 288, v0
    v_add_u32 v31, 8192, v30
    v_mov_b32 v40, 0
    v_mov_b32 v41, 0
    s_mov_b64 s[72:73], vcc
    s_cmp_lt_u32 s2, 6
    s_waitcnt lgkmcnt(0)
    s_cbranch_scc1 A_SPECIAL
A_EDGES:
    s_cbranch_vccz A_LOAD0
    s_mov_b64 exec, vcc
    global_load_dwordx4 v[48:51], v31, s[68:69]
    s_mov_b64 exec, -1
A_LOAD0:
    global_load_dwordx4 v[44:47], v30, s[68:69]
A_NOLOAD:
    s_getreg_b32 s50, hwreg(HW_REG_XCC_ID)
    s_lshl_b32 s53, s50, 6
    s_and_b32 s53, s53, 0x100
    s_cmp_eq_u32 s2, 9
    s_cselect_b32 s53, s53, 0
    s_or_b32 s53, s53, 1
    v_add_u32 v13, 65536, v12
    s_and_b32 s4, s2, 7
    s_lshl_b32 s4, s4, 5
    s_lshr_b32 s54, s2, 3
    s_add_u32 s4, s4, s54
    s_mul_i32 s5, s4, 196
    s_mov_b32 s12, s8
    s_mov_b32 s13, s9
    s_mov_b32 s16, s14
    s_mov_b32 s17, s15
    s_mov_b32 s18, 10485760
    s_mov_b32 s19, 0x20000
    s_add_u32 s20, s14, 12582912
    s_addc_u32 s21, s15, 0
    s_mov_b32 s22, 10485760
    s_mov_b32 s23, 0x20000
    s_add_u32 s24, s14, 100663296
    s_addc_u32 s25, s15, 0
    s_mov_b32 s26, 3467264
    s_mov_b32 s27, 0x20000
    s_mov_b32 s28, s64
    s_mov_b32 s29, s65
    s_mov_b32 s30, 6400000
    s_mov_b32 s31, 0x20000
    s_mov_b32 s32, s70
    s_mov_b32 s33, s71
    s_mov_b32 s34, 100000
    s_mov_b32 s35, 0x20000
    s_add_u32 s36, s14, 104202240
    s_addc_u32 s37, s15, 0
    s_mov_b32 s52, 0x800000
    v_and_b32 v1, 63, v0
    v_and_b32 v2, 7, v0
    v_lshlrev_b32 v2, 4, v2
    v_and_b32 v9, 1, v0
    v_and_b32 v6, 2, v0
    v_lshlrev_b32 v9, 4, v9
    v_cmp_eq_u32 vcc, 0, v6
    s_movk_i32 s54, 0x3f80
    v_lshlrev_b32 v9, v9, s54
    v_cndmask_b32 v6, 0, v9, vcc
    v_xor_b32 v7, v6, v9
    v_mov_b32 v174, 1
    s_and_b32 s54, s2, 15
    s_lshl_b32 s54, s54, 7
    v_lshl_add_u32 v172, v1, 11, s54
    s_lshr_b32 s54, s2, 4
    s_lshl_b32 s54, s54, 11
    v_lshl_add_u32 v173, v1, 7, s54
    v_lshrrev_b32 v8, 3, v1
    v_and_b32 v9, 1, v8
    v_mul_u32_u24 v9, 0x70, v9
    v_xor_b32 v4, v2, v9
    v_lshl_or_b32 v4, v8, 10, v4
    s_lshl_b32 s54, s3, 14
    v_or_b32 v4, s54, v4
    s_mul_i32 s54, s3, 1536
    s_add_u32 s54, s54, 139264
    v_lshl_add_u32 v5, v8, 6, s54
    v_lshrrev_b32 v9, 1, v0
    s_lshl_b32 s54, s4, 2
    s_add_u32 s54, s54, 3211264
    v_lshl_add_u32 v10, v9, 10, s54
    v_and_b32 v14, 1, v0
    v_mul_u32_u24 v9, 3200, v9
    v_lshlrev_b32 v14, 2, v14
    v_add_u32 v9, v9, v14
    v_mov_b32 v35, 0
    s_sub_u32 s54, s5, 8
    v_lshrrev_b32 v32, 3, v0
    v_add_u32 v32, s54, v32
    v_lshl_add_u32 v33, v32, 7, v2
    v_lshlrev_b32 v34, 1, v32
    v_mov_b32 v124, 0
    v_mov_b32 v125, 0
    v_mov_b32 v126, 0
    v_mov_b32 v127, 0
    v_mov_b32 v128, 0
    v_mov_b32 v129, 0
    v_mov_b32 v130, 0
    v_mov_b32 v131, 0
    s_cmp_ge_u32 s2, 6
    s_cbranch_scc1 A_SORT
    s_cmp_eq_u32 s3, 0
    s_cbranch_scc1 A_XLS
    s_movk_i32 s62, 7168
    s_movk_i32 s63, 14336
    s_movk_i32 s76, 21504
    buffer_load_dwordx4 v[108:111], v33, s[28:31], 0 offen
    buffer_load_short_d16_hi v124, v34, s[32:35], 0 offen offset:0
    buffer_load_dwordx4 v[112:115], v33, s[28:31], s62 offen
    buffer_load_short_d16_hi v125, v34, s[32:35], 0 offen offset:112
    buffer_load_dwordx4 v[116:119], v33, s[28:31], s63 offen
    buffer_load_short_d16_hi v126, v34, s[32:35], 0 offen offset:224
    s_mov_b64 exec, s[72:73]
    s_cbranch_execz A_XLS
    buffer_load_dwordx4 v[120:123], v33, s[28:31], s76 offen
    buffer_load_short_d16_hi v127, v34, s[32:35], 0 offen offset:336
A_XLS:
    s_mov_b64 exec, -1
    s_cmp_lg_u32 s2, 0
    s_cbranch_scc1 S_QUIET
    s_waitcnt vmcnt(8) lgkmcnt(0)
    s_sub_u32 s54, s3, 1
    s_cmp_lt_u32 s54, 4
    s_cbranch_scc1 S_Z
    s_waitcnt vmcnt(6)
    s_cmp_lg_u32 s3, 0
    s_cbranch_scc1 S_Z
    s_waitcnt vmcnt(0)
S_Z:
    s_barrier
    s_cmp_lg_u32 s3, 0
    s_cbranch_scc1 A_JOIN
    v_mov_b32 v35, 1
    s_mov_b64 exec, 1
    global_store_dword v175, v174, s[10:11] sc1
    s_mov_b64 exec, -1
    s_branch A_JOIN
S_QUIET:
    s_waitcnt vmcnt(0) lgkmcnt(0)
    s_barrier
    s_cmp_lg_u32 s3, 0
    s_cbranch_scc1 A_JOIN
    s_cmp_eq_u32 s2, 0
    s_cbranch_scc1 A_JOIN
    s_mov_b64 exec, 1
    s_mov_b32 s56, 0
    global_atomic_add v42, v40, v44, s[14:15] sc0
    global_atomic_add v43, v41, v44, s[14:15] sc0
    s_waitcnt vmcnt(1)
    s_nop 11
    s_getreg_b32 s57, hwreg(HW_REG_IB_STS, 0, 4)
    s_sub_i32 s56, s56, s57
    s_waitcnt vmcnt(0)
    global_atomic_add v42, v41, v44, s[14:15] sc0
    global_atomic_add v43, v40, v44, s[14:15] sc0
    s_waitcnt vmcnt(1)
    s_nop 11
    s_getreg_b32 s57, hwreg(HW_REG_IB_STS, 0, 4)
    s_add_i32 s56, s56, s57
    s_mov_b64 exec, -1
    global_load_dword v35, v175, s[10:11] sc1
    s_sub_i32 s57, 0, s56
    s_bitcmp0_b32 s50, 2
    s_cselect_b32 s56, s57, s56
    s_lshl_b32 s53, s56, 8
    s_or_b32 s53, s53, 1
    s_branch A_JOIN
A_SPECIAL:
    v_mov_b32 v44, 0
    s_cmp_lg_u32 s2, 0
    s_cbranch_scc1 S_PROBE
    v_add_u32 v40, 104202240, v12
    v_mov_b32 v45, 0
    v_mov_b32 v46, 0
    v_mov_b32 v47, 0
    global_store_dwordx4 v40, v[44:47], s[14:15] sc1
    v_add_u32 v40, 8192, v40
    global_store_dwordx4 v40, v[44:47], s[14:15] sc1
    v_add_u32 v40, 8192, v40
    global_store_dwordx4 v40, v[44:47], s[14:15] sc1
    v_add_u32 v40, 8192, v40
    global_store_dwordx4 v40, v[44:47], s[14:15] sc1
    v_add_u32 v40, 8192, v40
    s_branch A_NOLOAD
S_PROBE:
    s_cmp_lg_u32 s3, 0
    s_cbranch_scc1 A_NOLOAD
    s_and_b32 s54, s2, 1
    s_bfe_u32 s55, s2, 0x10001
    s_lshl_b32 s54, s54, 12
    s_lshl_b32 s55, s55, 14
    s_add_u32 s55, s55, s54
    s_and_b32 s54, s2, 7
    s_lshl_b32 s54, s54, 8
    s_add_u32 s55, s55, s54
    s_add_u32 s55, s55, 104169472
    v_lshl_add_u32 v40, v0, 13, s55
    s_mov_b64 exec, 3
    global_atomic_add v42, v40, v44, s[14:15] sc0
    s_mov_b64 exec, -1
    v_add_u32 v41, 8192, v40
    s_branch A_NOLOAD
A_SORT:
    s_mov_b32 s55, 21913099
    s_movk_i32 s56, 640
    s_movk_i32 s57, -196
    s_movk_i32 s58, 0x800
    v_mov_b32 v100, 0x809
    s_mov_b32 s59, 16384
    s_barrier
    global_load_dwordx4 v[52:55], v30, s[66:67]
    s_cmp_ge_u32 s3, 5
    s_cbranch_scc1 A_S1
    s_mov_b64 exec, s[72:73]
    global_load_dwordx4 v[56:59], v31, s[66:67]
    s_mov_b64 exec, -1
A_S1:
    s_cmp_ge_u32 s3, 5
    s_cbranch_scc1 A_ONE
    s_mov_b64 exec, s[72:73]
    s_waitcnt vmcnt(3)
    v_mul_hi_u32 v64, v48, s55
    v_mad_i32_i24 v48, v64, s57, v48
    v_add_lshl_u32 v64, v64, s59, 2
    ds_add_rtn_u32 v72, v64, v174
    v_mul_hi_u32 v65, v49, s55
    v_mad_i32_i24 v49, v65, s57, v49
    v_add_lshl_u32 v65, v65, s59, 2
    ds_add_rtn_u32 v73, v65, v174
    v_mul_hi_u32 v66, v50, s55
    v_mad_i32_i24 v50, v66, s57, v50
    v_add_lshl_u32 v66, v66, s59, 2
    ds_add_rtn_u32 v74, v66, v174
    v_mul_hi_u32 v67, v51, s55
    v_mad_i32_i24 v51, v67, s57, v51
    v_add_lshl_u32 v67, v67, s59, 2
    ds_add_rtn_u32 v75, v67, v174
    s_mov_b64 exec, -1
    s_waitcnt vmcnt(2)
    s_branch A_TWO
A_ONE:
    s_waitcnt vmcnt(1)
A_TWO:
    v_mul_hi_u32 v60, v44, s55
    v_mad_i32_i24 v44, v60, s57, v44
    v_add_lshl_u32 v60, v60, s59, 2
    ds_add_rtn_u32 v68, v60, v174
    v_mul_hi_u32 v61, v45, s55
    v_mad_i32_i24 v45, v61, s57, v45
    v_add_lshl_u32 v61, v61, s59, 2
    ds_add_rtn_u32 v69, v61, v174
    v_mul_hi_u32 v62, v46, s55
    v_mad_i32_i24 v46, v62, s57, v46
    v_add_lshl_u32 v62, v62, s59, 2
    ds_add_rtn_u32 v70, v62, v174
    v_mul_hi_u32 v63, v47, s55
    v_mad_i32_i24 v47, v63, s57, v47
    v_add_lshl_u32 v63, v63, s59, 2
    ds_add_rtn_u32 v71, v63, v174
    s_waitcnt lgkmcnt(0)
    s_barrier
    s_cmp_lg_u32 s3, 7
    s_cbranch_scc1 A_NOSCAN
    s_setprio 1
    v_subrev_u32 v36, 7168, v13
    ds_read_b128 v[16:19], v36
    s_lshl_b32 s54, s94, 10
    s_add_u32 s62, s54, 103867392
    s_add_u32 s63, s54, 104227840
    v_add_u32 v28, s62, v12
    v_add_u32 v29, s63, v12
    s_waitcnt lgkmcnt(0)
    v_add_u32 v21, v16, v17
    v_add_u32 v22, v21, v18
    v_add_u32 v23, v22, v19
    v_mov_b32 v20, v23
    s_nop 1
    v_add_u32_dpp v20, v20, v20 row_shr:1 row_mask:0xf bank_mask:0xf
    s_nop 1
    v_add_u32_dpp v20, v20, v20 row_shr:2 row_mask:0xf bank_mask:0xf
    s_nop 1
    v_add_u32_dpp v20, v20, v20 row_shr:4 row_mask:0xf bank_mask:0xf
    s_nop 1
    v_add_u32_dpp v20, v20, v20 row_shr:8 row_mask:0xf bank_mask:0xf
    s_nop 1
    v_add_u32_dpp v20, v20, v20 row_bcast:15 row_mask:0xa bank_mask:0xf
    s_nop 1
    v_add_u32_dpp v20, v20, v20 row_bcast:31 row_mask:0xc bank_mask:0xf
    v_sub_u32 v20, v20, v23
    v_add_u32 v23, v20, v22
    v_add_u32 v22, v20, v21
    v_add_u32 v21, v20, v16
    s_mov_b32 s54, 66560
    v_lshl_add_u32 v24, v20, 2, s54
    v_lshl_add_u32 v25, v21, 2, s54
    v_lshl_add_u32 v26, v22, 2, s54
    v_lshl_add_u32 v27, v23, 2, s54
    ds_write_b128 v36, v[24:27]
    s_waitcnt vmcnt(0)
    v_lshl_or_b32 v16, v16, 16, v20
    v_mov_b32 v36, 0
    v_lshl_or_b32 v17, v17, 16, v21
    v_mov_b32 v37, 0
    v_lshl_or_b32 v18, v18, 16, v22
    v_mov_b32 v38, 0
    v_lshl_or_b32 v19, v19, 16, v23
    v_mov_b32 v39, 0
    global_store_dwordx4 v28, v[16:19], s[14:15] sc1
    global_store_dwordx4 v29, v[36:39], s[14:15] sc1
    s_branch A_SRC
A_NOSCAN:
    s_waitcnt vmcnt(0)
    s_cmp_lt_u32 s3, 5
    s_cbranch_scc1 A_SRC
    s_waitcnt vmcnt(0)
A_SRC:
    s_cmp_eq_u32 s3, 0
    s_cbranch_scc1 A_XL
    s_movk_i32 s62, 7168
    s_movk_i32 s63, 14336
    s_movk_i32 s76, 21504
    buffer_load_dwordx4 v[108:111], v33, s[28:31], 0 offen
    buffer_load_short_d16_hi v124, v34, s[32:35], 0 offen offset:0
    buffer_load_dwordx4 v[112:115], v33, s[28:31], s62 offen
    buffer_load_short_d16_hi v125, v34, s[32:35], 0 offen offset:112
    buffer_load_dwordx4 v[116:119], v33, s[28:31], s63 offen
    buffer_load_short_d16_hi v126, v34, s[32:35], 0 offen offset:224
    s_mov_b64 exec, s[72:73]
    s_cbranch_execz A_XL
    buffer_load_dwordx4 v[120:123], v33, s[28:31], s76 offen
    buffer_load_short_d16_hi v127, v34, s[32:35], 0 offen offset:336
A_XL:
    s_mov_b64 exec, -1
    v_mul_hi_u32 v24, v52, s55
    v_mad_i32_i24 v52, v24, s57, v52
    v_bfe_u32 v25, v24, 4, 3
    v_cmp_gt_u32 vcc, 64, v52
    v_lshl_add_u32 v44, v44, 3, v25
    v_and_b32 v25, 0x7f, v24
    v_cndmask_b32 v26, 6, v100, vcc
    v_lshrrev_b32 v24, 7, v24
    v_mad_u32_u24 v76, v25, s56, v52
    v_lshlrev_b32 v24, v26, v24
    v_and_b32 v52, 0xc0, v52
    v_and_or_b32 v44, v26, s58, v44
    v_add3_u32 v76, v76, v52, v24
    v_lshrrev_b32 v24, 8, v76
    v_bitop3_b32 v76, v76, v24, 64 bitop3:0x78
    v_lshl_or_b32 v76, v76, 13, v44
    v_lshlrev_b32 v76, 2, v76
    v_mul_hi_u32 v24, v53, s55
    v_mad_i32_i24 v53, v24, s57, v53
    v_bfe_u32 v25, v24, 4, 3
    v_cmp_gt_u32 vcc, 64, v53
    v_lshl_add_u32 v45, v45, 3, v25
    v_and_b32 v25, 0x7f, v24
    v_cndmask_b32 v26, 6, v100, vcc
    v_lshrrev_b32 v24, 7, v24
    v_mad_u32_u24 v77, v25, s56, v53
    v_lshlrev_b32 v24, v26, v24
    v_and_b32 v53, 0xc0, v53
    v_and_or_b32 v45, v26, s58, v45
    v_add3_u32 v77, v77, v53, v24
    v_lshrrev_b32 v24, 8, v77
    v_bitop3_b32 v77, v77, v24, 64 bitop3:0x78
    v_lshl_or_b32 v77, v77, 13, v45
    v_lshlrev_b32 v77, 2, v77
    v_mul_hi_u32 v24, v54, s55
    v_mad_i32_i24 v54, v24, s57, v54
    v_bfe_u32 v25, v24, 4, 3
    v_cmp_gt_u32 vcc, 64, v54
    v_lshl_add_u32 v46, v46, 3, v25
    v_and_b32 v25, 0x7f, v24
    v_cndmask_b32 v26, 6, v100, vcc
    v_lshrrev_b32 v24, 7, v24
    v_mad_u32_u24 v78, v25, s56, v54
    v_lshlrev_b32 v24, v26, v24
    v_and_b32 v54, 0xc0, v54
    v_and_or_b32 v46, v26, s58, v46
    v_add3_u32 v78, v78, v54, v24
    v_lshrrev_b32 v24, 8, v78
    v_bitop3_b32 v78, v78, v24, 64 bitop3:0x78
    v_lshl_or_b32 v78, v78, 13, v46
    v_lshlrev_b32 v78, 2, v78
    v_mul_hi_u32 v24, v55, s55
    v_mad_i32_i24 v55, v24, s57, v55
    v_bfe_u32 v25, v24, 4, 3
    v_cmp_gt_u32 vcc, 64, v55
    v_lshl_add_u32 v47, v47, 3, v25
    v_and_b32 v25, 0x7f, v24
    v_cndmask_b32 v26, 6, v100, vcc
    v_lshrrev_b32 v24, 7, v24
    v_mad_u32_u24 v79, v25, s56, v55
    v_lshlrev_b32 v24, v26, v24
    v_and_b32 v55, 0xc0, v55
    v_and_or_b32 v47, v26, s58, v47
    v_add3_u32 v79, v79, v55, v24
    v_lshrrev_b32 v24, 8, v79
    v_bitop3_b32 v79, v79, v24, 64 bitop3:0x78
    v_lshl_or_b32 v79, v79, 13, v47
    v_lshlrev_b32 v79, 2, v79
    s_cmp_ge_u32 s3, 5
    s_cbranch_scc1 A_SRC1
    s_mov_b64 exec, s[72:73]
    v_mul_hi_u32 v24, v56, s55
    v_mad_i32_i24 v56, v24, s57, v56
    v_bfe_u32 v25, v24, 4, 3
    v_cmp_gt_u32 vcc, 64, v56
    v_lshl_add_u32 v48, v48, 3, v25
    v_and_b32 v25, 0x7f, v24
    v_cndmask_b32 v26, 6, v100, vcc
    v_lshrrev_b32 v24, 7, v24
    v_mad_u32_u24 v80, v25, s56, v56
    v_lshlrev_b32 v24, v26, v24
    v_and_b32 v56, 0xc0, v56
    v_and_or_b32 v48, v26, s58, v48
    v_add3_u32 v80, v80, v56, v24
    v_lshrrev_b32 v24, 8, v80
    v_bitop3_b32 v80, v80, v24, 64 bitop3:0x78
    v_lshl_or_b32 v80, v80, 13, v48
    v_lshlrev_b32 v80, 2, v80
    v_mul_hi_u32 v24, v57, s55
    v_mad_i32_i24 v57, v24, s57, v57
    v_bfe_u32 v25, v24, 4, 3
    v_cmp_gt_u32 vcc, 64, v57
    v_lshl_add_u32 v49, v49, 3, v25
    v_and_b32 v25, 0x7f, v24
    v_cndmask_b32 v26, 6, v100, vcc
    v_lshrrev_b32 v24, 7, v24
    v_mad_u32_u24 v81, v25, s56, v57
    v_lshlrev_b32 v24, v26, v24
    v_and_b32 v57, 0xc0, v57
    v_and_or_b32 v49, v26, s58, v49
    v_add3_u32 v81, v81, v57, v24
    v_lshrrev_b32 v24, 8, v81
    v_bitop3_b32 v81, v81, v24, 64 bitop3:0x78
    v_lshl_or_b32 v81, v81, 13, v49
    v_lshlrev_b32 v81, 2, v81
    v_mul_hi_u32 v24, v58, s55
    v_mad_i32_i24 v58, v24, s57, v58
    v_bfe_u32 v25, v24, 4, 3
    v_cmp_gt_u32 vcc, 64, v58
    v_lshl_add_u32 v50, v50, 3, v25
    v_and_b32 v25, 0x7f, v24
    v_cndmask_b32 v26, 6, v100, vcc
    v_lshrrev_b32 v24, 7, v24
    v_mad_u32_u24 v82, v25, s56, v58
    v_lshlrev_b32 v24, v26, v24
    v_and_b32 v58, 0xc0, v58
    v_and_or_b32 v50, v26, s58, v50
    v_add3_u32 v82, v82, v58, v24
    v_lshrrev_b32 v24, 8, v82
    v_bitop3_b32 v82, v82, v24, 64 bitop3:0x78
    v_lshl_or_b32 v82, v82, 13, v50
    v_lshlrev_b32 v82, 2, v82
    v_mul_hi_u32 v24, v59, s55
    v_mad_i32_i24 v59, v24, s57, v59
    v_bfe_u32 v25, v24, 4, 3
    v_cmp_gt_u32 vcc, 64, v59
    v_lshl_add_u32 v51, v51, 3, v25
    v_and_b32 v25, 0x7f, v24
    v_cndmask_b32 v26, 6, v100, vcc
    v_lshrrev_b32 v24, 7, v24
    v_mad_u32_u24 v83, v25, s56, v59
    v_lshlrev_b32 v24, v26, v24
    v_and_b32 v59, 0xc0, v59
    v_and_or_b32 v51, v26, s58, v51
    v_add3_u32 v83, v83, v59, v24
    v_lshrrev_b32 v24, 8, v83
    v_bitop3_b32 v83, v83, v24, 64 bitop3:0x78
    v_lshl_or_b32 v83, v83, 13, v51
    v_lshlrev_b32 v83, 2, v83
    s_mov_b64 exec, -1
    s_cmp_lg_u32 s3, 0
    s_cbranch_scc1 A_SRC1
    global_load_dword v35, v175, s[10:11] sc1
A_SRC1:
    s_setprio 0
    s_waitcnt lgkmcnt(0)
    s_barrier
    ds_read_b32 v60, v60
    ds_read_b32 v61, v61
    ds_read_b32 v62, v62
    ds_read_b32 v63, v63
    s_cmp_ge_u32 s3, 5
    s_cbranch_scc1 A_SC1
    s_mov_b64 exec, s[72:73]
    ds_read_b32 v64, v64
    ds_read_b32 v65, v65
    ds_read_b32 v66, v66
    ds_read_b32 v67, v67
    s_waitcnt lgkmcnt(0)
    v_lshl_add_u32 v64, v72, 2, v64
    ds_write_b32 v64, v80
    v_lshl_add_u32 v65, v73, 2, v65
    ds_write_b32 v65, v81
    v_lshl_add_u32 v66, v74, 2, v66
    ds_write_b32 v66, v82
    v_lshl_add_u32 v67, v75, 2, v67
    ds_write_b32 v67, v83
    s_mov_b64 exec, -1
    s_branch A_SC2
A_SC1:
    s_waitcnt lgkmcnt(0)
A_SC2:
    v_lshl_add_u32 v60, v68, 2, v60
    ds_write_b32 v60, v76
    v_lshl_add_u32 v61, v69, 2, v61
    ds_write_b32 v61, v77
    v_lshl_add_u32 v62, v70, 2, v62
    ds_write_b32 v62, v78
    v_lshl_add_u32 v63, v71, 2, v63
    ds_write_b32 v63, v79
    s_waitcnt lgkmcnt(0)
    s_barrier
    ds_read_b128 v[16:19], v13 offset:1024
    ds_read_b128 v[20:23], v13 offset:9216
    s_waitcnt lgkmcnt(1)
    buffer_store_dwordx4 v[16:19], v30, s[24:27], 0 offen sc1
    s_cmp_ge_u32 s3, 5
    s_cbranch_scc1 A_JOIN
    s_mov_b64 exec, s[72:73]
    s_waitcnt lgkmcnt(0)
    buffer_store_dwordx4 v[20:23], v31, s[24:27], 0 offen sc1
    s_mov_b64 exec, -1
A_JOIN:
    v_mov_b32 v24, 0
    v_mov_b32 v36, 2130706432
    v_mov_b32 v25, 0
    v_mov_b32 v37, 2130706432
    v_mov_b32 v26, 0
    v_mov_b32 v38, 2130706432
    v_mov_b32 v27, 0
    v_mov_b32 v39, 2130706432
    ds_write_b128 v12, v[24:27]
    ds_write_b128 v12, v[36:39] offset:8192
    ds_write_b128 v12, v[36:39] offset:16384
    ds_write_b128 v12, v[36:39] offset:24576
    ds_write_b128 v12, v[36:39] offset:32768
    ds_write_b128 v12, v[36:39] offset:40960
    ds_write_b128 v12, v[36:39] offset:49152
    ds_write_b128 v12, v[36:39] offset:57344
    s_waitcnt vmcnt(0) lgkmcnt(7)
    s_barrier
    s_cmp_lg_u32 s3, 0
    s_cbranch_scc1 A_XST
    s_mov_b32 s54, 0
    v_mov_b32 v40, s53
A_ZW:
    v_cmp_ne_u32 vcc, 0, v35
    s_cbranch_vccnz A_ZOK
    global_load_dword v35, v175, s[10:11] sc1
    s_add_u32 s54, s54, 1
    s_cmp_gt_u32 s54, s52
    s_waitcnt vmcnt(0)
    s_cbranch_scc0 A_ZW
A_ZOK:
    s_mov_b64 exec, 0xffff
    global_atomic_add v172, v40, s[36:37]
    s_mov_b64 exec, -1
    v_lshlrev_b32 v41, 2, v1
    s_mov_b32 s54, 0
    s_mov_b64 exec, 0xffff
POLL_A:
    s_add_u32 s54, s54, 1
    s_cmp_gt_u32 s54, s52
    s_cselect_b32 s52, 0, s52
    s_cbranch_scc1 POLLED_A
    global_atomic_add v168, v173, v175, s[36:37] sc0
POLLW_A:
    s_waitcnt vmcnt(0)
    v_and_b32 v42, 0xff, v168
    v_cmpx_ne_u32 vcc, 16, v42
    s_cbranch_execnz POLL_A
POLLED_A:
    s_mov_b64 exec, -1
    s_mov_b64 exec, 0xffff
    ds_write_b32 v41, v168 offset:6936
    s_mov_b64 exec, -1
    s_cmp_lg_u32 s2, 0
    s_waitcnt lgkmcnt(0)
    s_cbranch_scc1 A_DONE
    global_store_dword v175, v175, s[10:11] sc1
    s_branch A_DONE
A_XST:
    s_lshr_b32 s55, s4, 7
    s_and_b32 s58, s4, 127
    s_mul_i32 s58, s58, 10
    s_add_u32 s58, s58, s55
    s_lshl_b32 s58, s58, 6
    s_lshl_b32 s55, s55, 9
    v_mov_b32 v17, s55
    v_subrev_u32 v32, s5, v32
    v_mov_b32 v42, 0xffff0000
    v_add_u32 v43, 80896, v12
    v_lshrrev_b32 v16, 3, v0
    v_lshlrev_b32 v16, 2, v16
    v_add_u32 v16, 108512, v16
    s_waitcnt vmcnt(0)
    ds_write_b128 v43, v[108:111] offset:0
    ds_write_b32 v16, v124 offset:1024
    v_cmp_gt_u32 s[74:75], 64, v32
    v_and_b32 v40, 0xc0, v32
    s_nop 0
    v_cndmask_b32 v40, v40, v17, s[74:75]
    v_add3_u32 v128, v40, v32, s58
    v_lshrrev_b32 v40, 8, v128
    v_bitop3_b32 v128, v128, v40, 64 bitop3:0x78
    v_lshlrev_b32 v128, 7, v128
    ds_write_b32 v16, v128 offset:0
    v_lshlrev_b32 v40, 16, v108
    v_and_b32 v41, v42, v108
    v_mul_f32 v40, v40, v124
    v_mul_f32 v41, v41, v124
    v_cvt_pk_bf16_f32 v108, v40, v41
    v_lshlrev_b32 v40, 16, v109
    v_and_b32 v41, v42, v109
    v_mul_f32 v40, v40, v124
    v_mul_f32 v41, v41, v124
    v_cvt_pk_bf16_f32 v109, v40, v41
    v_lshlrev_b32 v40, 16, v110
    v_and_b32 v41, v42, v110
    v_mul_f32 v40, v40, v124
    v_mul_f32 v41, v41, v124
    v_cvt_pk_bf16_f32 v110, v40, v41
    v_lshlrev_b32 v40, 16, v111
    v_and_b32 v41, v42, v111
    v_mul_f32 v40, v40, v124
    v_mul_f32 v41, v41, v124
    v_cvt_pk_bf16_f32 v111, v40, v41
    v_or_b32 v128, v128, v2
    v_add_u32 v32, 56, v32
    v_xor_b32 v124, 0x2000, v128
    ds_write_b128 v43, v[112:115] offset:7168
    ds_write_b32 v16, v125 offset:1248
    v_cmp_gt_u32 s[76:77], 64, v32
    v_and_b32 v40, 0xc0, v32
    s_nop 0
    v_cndmask_b32 v40, v40, v17, s[76:77]
    v_add3_u32 v129, v40, v32, s58
    v_lshrrev_b32 v40, 8, v129
    v_bitop3_b32 v129, v129, v40, 64 bitop3:0x78
    v_lshlrev_b32 v129, 7, v129
    ds_write_b32 v16, v129 offset:224
    v_lshlrev_b32 v40, 16, v112
    v_and_b32 v41, v42, v112
    v_mul_f32 v40, v40, v125
    v_mul_f32 v41, v41, v125
    v_cvt_pk_bf16_f32 v112, v40, v41
    v_lshlrev_b32 v40, 16, v113
    v_and_b32 v41, v42, v113
    v_mul_f32 v40, v40, v125
    v_mul_f32 v41, v41, v125
    v_cvt_pk_bf16_f32 v113, v40, v41
    v_lshlrev_b32 v40, 16, v114
    v_and_b32 v41, v42, v114
    v_mul_f32 v40, v40, v125
    v_mul_f32 v41, v41, v125
    v_cvt_pk_bf16_f32 v114, v40, v41
    v_lshlrev_b32 v40, 16, v115
    v_and_b32 v41, v42, v115
    v_mul_f32 v40, v40, v125
    v_mul_f32 v41, v41, v125
    v_cvt_pk_bf16_f32 v115, v40, v41
    v_or_b32 v129, v129, v2
    v_add_u32 v32, 56, v32
    v_xor_b32 v125, 0x2000, v129
    ds_write_b128 v43, v[116:119] offset:14336
    ds_write_b32 v16, v126 offset:1472
    v_cmp_gt_u32 s[78:79], 64, v32
    v_and_b32 v40, 0xc0, v32
    s_nop 0
    v_cndmask_b32 v40, v40, v17, s[78:79]
    v_add3_u32 v130, v40, v32, s58
    v_lshrrev_b32 v40, 8, v130
    v_bitop3_b32 v130, v130, v40, 64 bitop3:0x78
    v_lshlrev_b32 v130, 7, v130
    ds_write_b32 v16, v130 offset:448
    v_lshlrev_b32 v40, 16, v116
    v_and_b32 v41, v42, v116
    v_mul_f32 v40, v40, v126
    v_mul_f32 v41, v41, v126
    v_cvt_pk_bf16_f32 v116, v40, v41
    v_lshlrev_b32 v40, 16, v117
    v_and_b32 v41, v42, v117
    v_mul_f32 v40, v40, v126
    v_mul_f32 v41, v41, v126
    v_cvt_pk_bf16_f32 v117, v40, v41
    v_lshlrev_b32 v40, 16, v118
    v_and_b32 v41, v42, v118
    v_mul_f32 v40, v40, v126
    v_mul_f32 v41, v41, v126
    v_cvt_pk_bf16_f32 v118, v40, v41
    v_lshlrev_b32 v40, 16, v119
    v_and_b32 v41, v42, v119
    v_mul_f32 v40, v40, v126
    v_mul_f32 v41, v41, v126
    v_cvt_pk_bf16_f32 v119, v40, v41
    v_or_b32 v130, v130, v2
    v_add_u32 v32, 56, v32
    s_mov_b64 exec, s[72:73]
    s_cbranch_execz A_XD
    ds_write_b128 v43, v[120:123] offset:21504
    ds_write_b32 v16, v127 offset:1696
    v_cmp_gt_u32 s[80:81], 64, v32
    v_and_b32 v40, 0xc0, v32
    s_nop 0
    v_cndmask_b32 v40, v40, v17, s[80:81]
    v_add3_u32 v131, v40, v32, s58
    v_lshrrev_b32 v40, 8, v131
    v_bitop3_b32 v131, v131, v40, 64 bitop3:0x78
    v_lshlrev_b32 v131, 7, v131
    ds_write_b32 v16, v131 offset:672
    v_lshlrev_b32 v40, 16, v120
    v_and_b32 v41, v42, v120
    v_mul_f32 v40, v40, v127
    v_mul_f32 v41, v41, v127
    v_cvt_pk_bf16_f32 v120, v40, v41
    v_lshlrev_b32 v40, 16, v121
    v_and_b32 v41, v42, v121
    v_mul_f32 v40, v40, v127
    v_mul_f32 v41, v41, v127
    v_cvt_pk_bf16_f32 v121, v40, v41
    v_lshlrev_b32 v40, 16, v122
    v_and_b32 v41, v42, v122
    v_mul_f32 v40, v40, v127
    v_mul_f32 v41, v41, v127
    v_cvt_pk_bf16_f32 v122, v40, v41
    v_lshlrev_b32 v40, 16, v123
    v_and_b32 v41, v42, v123
    v_mul_f32 v40, v40, v127
    v_mul_f32 v41, v41, v127
    v_cvt_pk_bf16_f32 v123, v40, v41
    v_or_b32 v131, v131, v2
    v_add_u32 v32, 56, v32
A_XD:
    s_mov_b64 exec, -1
    s_waitcnt lgkmcnt(0)
A_DONE:
    s_add_u32 s36, s36, 32768
    s_addc_u32 s37, s37, 0
    s_barrier
    buffer_load_dword v11, v10, s[24:27], 0 offen sc1
    ds_read_b128 v[16:19], v175 offset:6944
    ds_read_b32 v20, v175 offset:6940
    ds_read_b32 v105, v175 offset:6972
    s_waitcnt vmcnt(0)
    v_and_b32 v15, 0xffff, v11
    v_lshrrev_b32 v11, 16, v11
    v_add_lshl_u32 v9, v9, v15, 2
    v_sub_u32 v104, v11, v14
    v_cmpx_lt_i32 vcc, 0, v104
    s_cbranch_execz K2_LD_DONE
    buffer_load_dwordx4 v[44:47], v9, s[24:27], 0 offen offset:0
    v_cmpx_lt_i32 vcc, 8, v104
    s_cbranch_execz K2_LD_DONE
    buffer_load_dwordx4 v[48:51], v9, s[24:27], 0 offen offset:32
    v_cmpx_lt_i32 vcc, 16, v104
    s_cbranch_execz K2_LD_DONE
    buffer_load_dwordx4 v[52:55], v9, s[24:27], 0 offen offset:64
    v_cmpx_lt_i32 vcc, 24, v104
    s_cbranch_execz K2_LD_DONE
    buffer_load_dwordx4 v[56:59], v9, s[24:27], 0 offen offset:96
    v_cmpx_lt_i32 vcc, 32, v104
    s_cbranch_execz K2_LD_DONE
    buffer_load_dwordx4 v[60:63], v9, s[24:27], 0 offen offset:128
K2_LD_DONE:
    s_mov_b64 exec, -1
    v_cmp_lt_u32 vcc, 40, v11
    s_cbranch_vccz K2_LEN_OK
    v_mov_b32 v15, 6912
    ds_write_b32 v15, v174
K2_LEN_OK:
    s_lshl_b32 s50, s50, 11
    s_and_b32 s50, s50, 0x2000
    s_movk_i32 s54, 0xff80
    s_waitcnt lgkmcnt(0)
    v_add3_u32 v16, v16, v17, v18
    v_add3_u32 v16, v16, v19, v20
    v_cmp_lt_i32 vcc, 0xff, v16
    v_mov_b32 v15, s50
    v_xor_b32 v16, 0x2000, v15
    v_cndmask_b32 v15, v15, v16, vcc
    s_and_b32 s56, s2, 15
    s_lshl_b32 s56, s56, 7
    v_lshl_add_u32 v172, v1, 11, s56
    s_bfe_u32 s56, s2, 0x20003
    s_bfe_u32 s57, s2, 0x10005
    s_lshl_b32 s56, s56, 11
    s_lshl_b32 s57, s57, 14
    s_or_b32 s56, s56, s57
    s_xor_b32 s56, s56, 8192
    v_lshl_add_u32 v173, v1, 7, s56
    v_xor_b32 v173, v173, v15
    v_lshlrev_b32 v105, 5, v105
    v_xor_b32 v16, s50, v15
    v_and_b32 v105, 0x2000, v105
    v_xor_b32 v105, v105, v16
    v_xor_b32 v15, v15, v105
    v_xor_b32 v124, v124, v105
    v_xor_b32 v125, v125, v105
    v_xor_b32 v128, v128, v105
    v_xor_b32 v129, v129, v105
    v_xor_b32 v130, v130, v105
    v_xor_b32 v131, v131, v105
    s_barrier
    s_cmp_eq_u32 s3, 0
    s_cbranch_scc1 K2_X0
    buffer_store_dwordx4 v[108:111], v124, s[16:19], 0 offen sc1
    buffer_store_dwordx4 v[108:111], v128, s[16:19], 0 offen sc1
    s_cmp_lg_u32 s3, 1
    s_cbranch_scc1 K2_X1
    buffer_store_dwordx4 v[112:115], v125, s[16:19], 0 offen sc1
K2_X1:
    buffer_store_dwordx4 v[112:115], v129, s[16:19], 0 offen sc1
    buffer_store_dwordx4 v[116:119], v130, s[16:19], 0 offen sc1
    s_cmp_ge_u32 s3, 5
    s_cbranch_scc1 K2_X6
    s_mov_b64 exec, s[72:73]
    buffer_store_dwordx4 v[120:123], v131, s[16:19], 0 offen sc1
    s_mov_b64 exec, -1
    s_waitcnt vmcnt(6)
    s_cmp_eq_u32 s3, 1
    s_cbranch_scc1 K2_WD
    s_waitcnt vmcnt(5)
    s_branch K2_WD
K2_X0:
    s_waitcnt vmcnt(0)
K2_X6:
    s_waitcnt vmcnt(4)
K2_WD:
    v_cmpx_lt_i32 s[56:57], 0, v104
    s_cbranch_execz K2_A_DONE
    v_and_b32 v64, 0x1fff, v44
    v_and_b32 v17, v15, v44
    ds_add_rtn_u32 v84, v64, v174
    v_lshrrev_b32 v44, 8, v44
    v_bitop3_b32 v44, v17, v44, s54 bitop3:0x78
    v_cmpx_lt_i32 s[58:59], 1, v104
    v_and_b32 v65, 0x1fff, v45
    v_and_b32 v17, v15, v45
    ds_add_rtn_u32 v85, v65, v174
    v_lshrrev_b32 v45, 8, v45
    v_bitop3_b32 v45, v17, v45, s54 bitop3:0x78
    v_cmpx_lt_i32 s[60:61], 2, v104
    s_cbranch_execz K2_A_DONE
    v_and_b32 v66, 0x1fff, v46
    v_and_b32 v17, v15, v46
    ds_add_rtn_u32 v86, v66, v174
    v_lshrrev_b32 v46, 8, v46
    v_bitop3_b32 v46, v17, v46, s54 bitop3:0x78
    v_cmpx_lt_i32 s[62:63], 3, v104
    v_and_b32 v67, 0x1fff, v47
    v_and_b32 v17, v15, v47
    ds_add_rtn_u32 v87, v67, v174
    v_lshrrev_b32 v47, 8, v47
    v_bitop3_b32 v47, v17, v47, s54 bitop3:0x78
    v_cmpx_lt_i32 s[64:65], 8, v104
    s_cbranch_execz K2_A_DONE
    v_and_b32 v68, 0x1fff, v48
    v_and_b32 v17, v15, v48
    ds_add_rtn_u32 v88, v68, v174
    v_lshrrev_b32 v48, 8, v48
    v_bitop3_b32 v48, v17, v48, s54 bitop3:0x78
    v_cmpx_lt_i32 s[66:67], 9, v104
    v_and_b32 v69, 0x1fff, v49
    v_and_b32 v17, v15, v49
    ds_add_rtn_u32 v89, v69, v174
    v_lshrrev_b32 v49, 8, v49
    v_bitop3_b32 v49, v17, v49, s54 bitop3:0x78
    v_cmpx_lt_i32 s[68:69], 10, v104
    s_cbranch_execz K2_A_DONE
    v_and_b32 v70, 0x1fff, v50
    v_and_b32 v17, v15, v50
    ds_add_rtn_u32 v90, v70, v174
    v_lshrrev_b32 v50, 8, v50
    v_bitop3_b32 v50, v17, v50, s54 bitop3:0x78
    v_cmpx_lt_i32 s[70:71], 11, v104
    v_and_b32 v71, 0x1fff, v51
    v_and_b32 v17, v15, v51
    ds_add_rtn_u32 v91, v71, v174
    v_lshrrev_b32 v51, 8, v51
    v_bitop3_b32 v51, v17, v51, s54 bitop3:0x78
    v_cmpx_lt_i32 s[72:73], 16, v104
    s_cbranch_execz K2_A_DONE
    v_and_b32 v72, 0x1fff, v52
    v_and_b32 v17, v15, v52
    ds_add_rtn_u32 v92, v72, v174
    v_lshrrev_b32 v52, 8, v52
    v_bitop3_b32 v52, v17, v52, s54 bitop3:0x78
    v_cmpx_lt_i32 s[74:75], 17, v104
    v_and_b32 v73, 0x1fff, v53
    v_and_b32 v17, v15, v53
    ds_add_rtn_u32 v93, v73, v174
    v_lshrrev_b32 v53, 8, v53
    v_bitop3_b32 v53, v17, v53, s54 bitop3:0x78
    v_cmpx_lt_i32 s[76:77], 18, v104
    s_cbranch_execz K2_A_DONE
    v_and_b32 v74, 0x1fff, v54
    v_and_b32 v17, v15, v54
    ds_add_rtn_u32 v94, v74, v174
    v_lshrrev_b32 v54, 8, v54
    v_bitop3_b32 v54, v17, v54, s54 bitop3:0x78
    v_cmpx_lt_i32 s[78:79], 19, v104
    v_and_b32 v75, 0x1fff, v55
    v_and_b32 v17, v15, v55
    ds_add_rtn_u32 v95, v75, v174
    v_lshrrev_b32 v55, 8, v55
    v_bitop3_b32 v55, v17, v55, s54 bitop3:0x78
    v_cmpx_lt_i32 s[80:81], 24, v104
    s_cbranch_execz K2_A_DONE
    v_and_b32 v76, 0x1fff, v56
    v_and_b32 v17, v15, v56
    ds_add_rtn_u32 v96, v76, v174
    v_lshrrev_b32 v56, 8, v56
    v_bitop3_b32 v56, v17, v56, s54 bitop3:0x78
    v_cmpx_lt_i32 s[82:83], 25, v104
    v_and_b32 v77, 0x1fff, v57
    v_and_b32 v17, v15, v57
    ds_add_rtn_u32 v97, v77, v174
    v_lshrrev_b32 v57, 8, v57
    v_bitop3_b32 v57, v17, v57, s54 bitop3:0x78
    v_cmpx_lt_i32 s[84:85], 26, v104
    s_cbranch_execz K2_A_DONE
    v_and_b32 v78, 0x1fff, v58
    v_and_b32 v17, v15, v58
    ds_add_rtn_u32 v98, v78, v174
    v_lshrrev_b32 v58, 8, v58
    v_bitop3_b32 v58, v17, v58, s54 bitop3:0x78
    v_cmpx_lt_i32 s[86:87], 27, v104
    v_and_b32 v79, 0x1fff, v59
    v_and_b32 v17, v15, v59
    ds_add_rtn_u32 v99, v79, v174
    v_lshrrev_b32 v59, 8, v59
    v_bitop3_b32 v59, v17, v59, s54 bitop3:0x78
    v_cmpx_lt_i32 s[88:89], 32, v104
    s_cbranch_execz K2_A_DONE
    v_and_b32 v80, 0x1fff, v60
    v_and_b32 v17, v15, v60
    ds_add_rtn_u32 v100, v80, v174
    v_lshrrev_b32 v60, 8, v60
    v_bitop3_b32 v60, v17, v60, s54 bitop3:0x78
    v_cmpx_lt_i32 s[90:91], 33, v104
    v_and_b32 v81, 0x1fff, v61
    v_and_b32 v17, v15, v61
    ds_add_rtn_u32 v101, v81, v174
    v_lshrrev_b32 v61, 8, v61
    v_bitop3_b32 v61, v17, v61, s54 bitop3:0x78
    v_cmpx_lt_i32 s[92:93], 34, v104
    s_cbranch_execz K2_A_DONE
    v_and_b32 v82, 0x1fff, v62
    v_and_b32 v17, v15, v62
    ds_add_rtn_u32 v102, v82, v174
    v_lshrrev_b32 v62, 8, v62
    v_bitop3_b32 v62, v17, v62, s54 bitop3:0x78
    v_cmpx_lt_i32 s[94:95], 35, v104
    v_and_b32 v83, 0x1fff, v63
    v_and_b32 v17, v15, v63
    ds_add_rtn_u32 v103, v83, v174
    v_lshrrev_b32 v63, 8, v63
    v_bitop3_b32 v63, v17, v63, s54 bitop3:0x78
K2_A_DONE:
    s_mov_b64 exec, -1
    s_waitcnt lgkmcnt(0)
    s_barrier
    s_cmp_ge_u32 s3, 4
    s_cbranch_scc1 K2_P2_DONE
    v_cmpx_gt_u32 vcc, 208, v0
    v_lshlrev_b32 v40, 5, v0
    ds_read_b128 v[16:19], v40
    ds_read_b128 v[32:35], v40 offset:16
    v_mul_u32_u24 v20, 260, v0
    v_add_u32 v20, 8192, v20
    v_lshl_or_b32 v27, v0, 16, v20
    s_waitcnt lgkmcnt(1)
    v_lshl_add_u32 v21, v16, 2, v20
    v_lshl_add_u32 v22, v17, 2, v21
    v_lshl_add_u32 v23, v18, 2, v22
    v_lshl_add_u32 v36, v19, 2, v23
    ds_write_b128 v40, v[20:23]
    s_waitcnt lgkmcnt(1)
    v_lshl_add_u32 v37, v32, 2, v36
    v_lshl_add_u32 v38, v33, 2, v37
    v_lshl_add_u32 v39, v34, 2, v38
    v_lshl_add_u32 v24, v35, 2, v39
    ds_write_b128 v40, v[36:39] offset:16
    v_sub_u32 v24, v24, v20
    v_min_u32 v25, 0xfc, v24
    v_sub_u32 v26, 0xfc, v25
    v_cmpx_gt_u32 vcc, 196, v0
    ds_add_rtn_u32 v28, v26, v174 offset:6656
    s_mov_b64 exec, -1
K2_P2_DONE:
    s_waitcnt lgkmcnt(0)
    v_lshlrev_b32 v29, 2, v1
    v_mov_b32 v15, 6912
    s_waitcnt vmcnt(0)
    s_barrier
    s_cmp_lg_u32 s3, 4
    s_cbranch_scc1 K2_NOSIG
    s_mov_b64 exec, 0xffff
    global_atomic_add v172, v174, s[36:37]
    s_mov_b64 exec, -1
K2_NOSIG:
    ds_read_b32 v30, v29 offset:6656
    ds_read_b32 v15, v15
    s_mov_b64 exec, s[56:57]
    s_cbranch_execz K2_B_DONE
    ds_read_b32 v64, v64
    s_mov_b64 exec, s[58:59]
    ds_read_b32 v65, v65
    s_mov_b64 exec, s[60:61]
    s_cbranch_execz K2_B_DONE
    ds_read_b32 v66, v66
    s_mov_b64 exec, s[62:63]
    ds_read_b32 v67, v67
    s_mov_b64 exec, s[64:65]
    s_cbranch_execz K2_B_DONE
    ds_read_b32 v68, v68
    s_mov_b64 exec, s[66:67]
    ds_read_b32 v69, v69
    s_mov_b64 exec, s[68:69]
    s_cbranch_execz K2_B_DONE
    ds_read_b32 v70, v70
    s_mov_b64 exec, s[70:71]
    ds_read_b32 v71, v71
    s_mov_b64 exec, s[72:73]
    s_cbranch_execz K2_B_DONE
    ds_read_b32 v72, v72
    s_mov_b64 exec, s[74:75]
    ds_read_b32 v73, v73
    s_mov_b64 exec, s[76:77]
    s_cbranch_execz K2_B_DONE
    ds_read_b32 v74, v74
    s_mov_b64 exec, s[78:79]
    ds_read_b32 v75, v75
    s_mov_b64 exec, s[80:81]
    s_cbranch_execz K2_B_DONE
    ds_read_b32 v76, v76
    s_mov_b64 exec, s[82:83]
    ds_read_b32 v77, v77
    s_mov_b64 exec, s[84:85]
    s_cbranch_execz K2_B_DONE
    ds_read_b32 v78, v78
    s_mov_b64 exec, s[86:87]
    ds_read_b32 v79, v79
    s_mov_b64 exec, s[88:89]
    s_cbranch_execz K2_B_DONE
    ds_read_b32 v80, v80
    s_mov_b64 exec, s[90:91]
    ds_read_b32 v81, v81
    s_mov_b64 exec, s[92:93]
    s_cbranch_execz K2_B_DONE
    ds_read_b32 v82, v82
    s_mov_b64 exec, s[94:95]
    ds_read_b32 v83, v83
K2_B_DONE:
    s_mov_b64 exec, -1
    s_mov_b32 s38, 0x19171600
    s_mov_b32 s39, 0x19110705
    s_mov_b32 s40, 0x190c0b06
    s_mov_b32 s41, 0x19130803
    s_mov_b32 s42, 0x19140902
    s_mov_b32 s43, 0x19100a04
    s_mov_b32 s44, 0x19120f01
    s_mov_b32 s45, 0x18150e0d
    s_mov_b32 m0, s3
    v_lshlrev_b32 v9, 2, v8
    s_movrels_b32 s55, s38
    v_add_u32 v9, 7040, v9
    s_waitcnt lgkmcnt(0)
    v_readfirstlane_b32 s54, v30
    v_mov_b32 v31, v30
    s_cmp_lg_u32 s54, 0
    s_cbranch_scc1 K2_C_DONE
    s_mov_b64 exec, s[56:57]
    s_cbranch_execz K2_C_DONE
    v_lshl_add_u32 v64, v84, 2, v64
    ds_write_b32 v64, v44
    s_mov_b64 exec, s[58:59]
    v_lshl_add_u32 v65, v85, 2, v65
    ds_write_b32 v65, v45
    s_mov_b64 exec, s[60:61]
    s_cbranch_execz K2_C_DONE
    v_lshl_add_u32 v66, v86, 2, v66
    ds_write_b32 v66, v46
    s_mov_b64 exec, s[62:63]
    v_lshl_add_u32 v67, v87, 2, v67
    ds_write_b32 v67, v47
    s_mov_b64 exec, s[64:65]
    s_cbranch_execz K2_C_DONE
    v_lshl_add_u32 v68, v88, 2, v68
    ds_write_b32 v68, v48
    s_mov_b64 exec, s[66:67]
    v_lshl_add_u32 v69, v89, 2, v69
    ds_write_b32 v69, v49
    s_mov_b64 exec, s[68:69]
    s_cbranch_execz K2_C_DONE
    v_lshl_add_u32 v70, v90, 2, v70
    ds_write_b32 v70, v50
    s_mov_b64 exec, s[70:71]
    v_lshl_add_u32 v71, v91, 2, v71
    ds_write_b32 v71, v51
    s_mov_b64 exec, s[72:73]
    s_cbranch_execz K2_C_DONE
    v_lshl_add_u32 v72, v92, 2, v72
    ds_write_b32 v72, v52
    s_mov_b64 exec, s[74:75]
    v_lshl_add_u32 v73, v93, 2, v73
    ds_write_b32 v73, v53
    s_mov_b64 exec, s[76:77]
    s_cbranch_execz K2_C_DONE
    v_lshl_add_u32 v74, v94, 2, v74
    ds_write_b32 v74, v54
    s_mov_b64 exec, s[78:79]
    v_lshl_add_u32 v75, v95, 2, v75
    ds_write_b32 v75, v55
    s_mov_b64 exec, s[80:81]
    s_cbranch_execz K2_C_DONE
    v_lshl_add_u32 v76, v96, 2, v76
    ds_write_b32 v76, v56
    s_mov_b64 exec, s[82:83]
    v_lshl_add_u32 v77, v97, 2, v77
    ds_write_b32 v77, v57
    s_mov_b64 exec, s[84:85]
    s_cbranch_execz K2_C_DONE
    v_lshl_add_u32 v78, v98, 2, v78
    ds_write_b32 v78, v58
    s_mov_b64 exec, s[86:87]
    v_lshl_add_u32 v79, v99, 2, v79
    ds_write_b32 v79, v59
    s_mov_b64 exec, s[88:89]
    s_cbranch_execz K2_C_DONE
    v_lshl_add_u32 v80, v100, 2, v80
    ds_write_b32 v80, v60
    s_mov_b64 exec, s[90:91]
    v_lshl_add_u32 v81, v101, 2, v81
    ds_write_b32 v81, v61
    s_mov_b64 exec, s[92:93]
    s_cbranch_execz K2_C_DONE
    v_lshl_add_u32 v82, v102, 2, v82
    ds_write_b32 v82, v62
    s_mov_b64 exec, s[94:95]
    v_lshl_add_u32 v83, v103, 2, v83
    ds_write_b32 v83, v63
K2_C_DONE:
    s_mov_b64 exec, -1
    s_nop 1
    v_add_u32_dpp v31, v31, v31 row_shr:1 row_mask:0xf bank_mask:0xf
    s_nop 1
    v_add_u32_dpp v31, v31, v31 row_shr:2 row_mask:0xf bank_mask:0xf
    s_nop 1
    v_add_u32_dpp v31, v31, v31 row_shr:4 row_mask:0xf bank_mask:0xf
    s_nop 1
    v_add_u32_dpp v31, v31, v31 row_shr:8 row_mask:0xf bank_mask:0xf
    s_nop 1
    v_add_u32_dpp v31, v31, v31 row_bcast:15 row_mask:0xa bank_mask:0xf
    s_nop 1
    v_add_u32_dpp v31, v31, v31 row_bcast:31 row_mask:0xc bank_mask:0xf
    v_readfirstlane_b32 s51, v15
    s_cmp_ge_u32 s3, 4
    s_cbranch_scc1 K2_P3_SKIP
    v_sub_u32 v32, v31, v30
    ds_bpermute_b32 v32, v26, v32
    v_cmp_gt_u32 vcc, 196, v0
    s_waitcnt lgkmcnt(0)
    v_add_u32 v32, v32, v28
    v_cndmask_b32 v32, v0, v32, vcc
    v_lshlrev_b32 v32, 2, v32
    v_cmpx_gt_u32 vcc, 208, v0
    ds_write_b32 v32, v27 offset:7040
    s_mov_b64 exec, -1
K2_P3_SKIP:
    s_or_b32 s51, s51, s54
    s_cmp_lg_u32 s3, 4
    s_cbranch_scc1 K2_NOPRE
    s_mov_b64 exec, 0xffff
    global_atomic_add v168, v173, v175, s[36:37] sc0
    s_mov_b64 exec, -1
K2_NOPRE:
    s_bfe_u32 s64, s55, 0x80000
    s_lshl_b32 s64, s64, 3
    v_cmp_ge_u32 s[74:75], s64, v31
    v_lshl_add_u32 v24, s64, 2, v9
    s_bfe_u32 s65, s55, 0x80008
    s_lshl_b32 s65, s65, 3
    v_cmp_ge_u32 s[76:77], s65, v31
    v_lshl_add_u32 v25, s65, 2, v9
    s_bfe_u32 s66, s55, 0x80010
    s_lshl_b32 s66, s66, 3
    v_cmp_ge_u32 s[78:79], s66, v31
    v_lshl_add_u32 v26, s66, 2, v9
    s_bfe_u32 s67, s55, 0x80018
    s_lshl_b32 s67, s67, 3
    v_cmp_ge_u32 s[80:81], s67, v31
    v_lshl_add_u32 v27, s67, 2, v9
    s_bcnt1_i32_b64 s56, s[74:75]
    s_sub_i32 s56, 63, s56
    s_max_i32 s68, s56, 0
    s_bcnt1_i32_b64 s56, s[76:77]
    s_sub_i32 s56, 63, s56
    s_max_i32 s69, s56, 0
    s_bcnt1_i32_b64 s56, s[78:79]
    s_sub_i32 s56, 63, s56
    s_max_i32 s70, s56, 0
    s_bcnt1_i32_b64 s56, s[80:81]
    s_sub_i32 s56, 63, s56
    s_max_i32 s71, s56, 0
    s_add_u32 s72, s68, s69
    s_add_u32 s73, s72, s70
    s_add_u32 s7, s73, s71
    v_cmp_le_u32 s[74:75], s68, v1
    v_cmp_le_u32 s[76:77], s72, v1
    v_cmp_le_u32 s[78:79], s73, v1
    v_cmp_le_u32 s[80:81], s7, v1
    s_cmp_gt_u32 s7, 64
    s_cselect_b32 s51, 1, s51
    s_lshl_b32 s54, s3, 8
    s_add_u32 s54, s54, 62464
    s_sub_u32 s57, s68, 0
    v_mov_b32 v16, v1
    v_mov_b32 v17, s57
    v_mov_b32 v18, 0x100
    s_mov_b64 exec, s[74:75]
    v_subrev_u32 v16, s68, v1
    v_mov_b32 v17, s69
    v_mov_b32 v18, 0x302
    s_mov_b64 exec, s[76:77]
    v_subrev_u32 v16, s72, v1
    v_mov_b32 v17, s70
    v_mov_b32 v18, 0x504
    s_mov_b64 exec, s[78:79]
    v_subrev_u32 v16, s73, v1
    v_mov_b32 v17, s71
    v_mov_b32 v18, 0x706
    s_mov_b64 exec, -1
    v_cvt_f32_u32 v19, v17
    v_lshl_or_b32 v20, v16, 1, 1
    v_rcp_f32 v19, v19
    v_add_u32 v21, -1, v17
    v_lshl_or_b32 v18, v16, 18, v18
    v_mul_f32 v22, 0.5, v19
    v_mul_f32 v19, 0x3e800000, v19
    v_cndmask_b32 v32, v21, v17, s[74:75]
    v_cndmask_b32 v33, v21, v17, s[76:77]
    v_cndmask_b32 v34, v21, v17, s[78:79]
    v_mad_u32_u24 v32, v20, s57, v32
    v_mad_u32_u24 v33, v20, s69, v33
    v_mad_u32_u24 v34, v20, s70, v34
    v_mad_u32_u24 v35, v20, s71, v21
    v_cvt_f32_u32 v32, v32
    v_cvt_f32_u32 v33, v33
    v_cvt_f32_u32 v34, v34
    v_cvt_f32_u32 v35, v35
    v_fma_f32 v32, v32, v22, v19
    v_fma_f32 v33, v33, v22, v19
    v_fma_f32 v34, v34, v22, v19
    v_fma_f32 v35, v35, v22, v19
    v_cvt_u32_f32 v32, v32
    v_cvt_u32_f32 v33, v33
    v_cvt_u32_f32 v34, v34
    v_cvt_u32_f32 v35, v35
    v_add3_u32 v20, v32, v33, v34
    v_and_b32 v22, 3, v1
    v_add_u32 v20, v20, v35
    s_mov_b64 exec, s[80:81]
    v_mov_b32 v20, v1
    v_mov_b32 v18, 0x1000100
    s_mov_b64 exec, -1
    v_and_b32 v20, 63, v20
    v_add_u32 v21, s54, v29
    v_lshl_add_u32 v20, v20, 2, s54
    v_lshl_add_u32 v22, v22, 4, s54
    ds_write_b32 v20, v18
    ds_read_b128 v[44:47], v22 offset:0
    ds_read_b128 v[48:51], v22 offset:64
    ds_read_b128 v[52:55], v22 offset:128
    ds_read_b128 v[56:59], v22 offset:192
    ds_read_b32 v21, v21
    s_cmp_lg_u32 s3, 4
    s_cbranch_scc1 K2_NOP1
    s_mov_b32 s54, 0
    s_mov_b64 exec, 0xffff
    s_branch POLLW_X
POLL_X:
    s_add_u32 s54, s54, 1
    s_cmp_gt_u32 s54, s52
    s_cselect_b32 s52, 0, s52
    s_cbranch_scc1 POLLED_X
    global_atomic_add v168, v173, v175, s[36:37] sc0
POLLW_X:
    s_waitcnt vmcnt(0)
    v_cmpx_ne_u32 s[56:57], 16, v168
    s_cbranch_execnz POLL_X
POLLED_X:
    s_mov_b64 exec, -1
K2_NOP1:
    s_mov_b32 s58, 0x01010101
    s_mov_b32 s59, 0x01010101
    s_mov_b32 s63, 0xffff
    s_mov_b32 s6, 1
    s_mov_b32 s56, 0x05040100
    s_waitcnt vmcnt(0) lgkmcnt(0)
    s_barrier
    ds_read_b32 v24, v24
    ds_read_b32 v25, v25
    ds_read_b32 v26, v26
    ds_read_b32 v27, v27
    v_and_b32 v22, 2, v21
    v_and_b32 v23, 4, v21
    v_cmp_ne_u32 s[74:75], 0, v22
    v_cmp_ne_u32 s[76:77], 0, v23
    s_waitcnt lgkmcnt(0)
    v_perm_b32 v16, v25, v24, s56
    v_perm_b32 v17, v27, v26, s56
    v_perm_b32 v60, v17, v16, v44
    v_perm_b32 v61, v17, v16, v45
    v_perm_b32 v62, v17, v16, v46
    v_perm_b32 v63, v17, v16, v47
    v_add_u32_sdwa v60, v60, v44 dst_sel:DWORD dst_unused:UNUSED_PAD src0_sel:WORD_0 src1_sel:WORD_1
    v_add_u32_sdwa v61, v61, v45 dst_sel:DWORD dst_unused:UNUSED_PAD src0_sel:WORD_0 src1_sel:WORD_1
    v_add_u32_sdwa v62, v62, v46 dst_sel:DWORD dst_unused:UNUSED_PAD src0_sel:WORD_0 src1_sel:WORD_1
    v_add_u32_sdwa v63, v63, v47 dst_sel:DWORD dst_unused:UNUSED_PAD src0_sel:WORD_0 src1_sel:WORD_1
    ds_read_b32 v28, v60
    ds_read_b32 v29, v61
    ds_read_b32 v30, v62
    ds_read_b32 v31, v63
    v_perm_b32 v64, v17, v16, v48
    v_perm_b32 v65, v17, v16, v49
    v_perm_b32 v66, v17, v16, v50
    v_perm_b32 v67, v17, v16, v51
    v_add_u32_sdwa v64, v64, v48 dst_sel:DWORD dst_unused:UNUSED_PAD src0_sel:WORD_0 src1_sel:WORD_1
    v_add_u32_sdwa v65, v65, v49 dst_sel:DWORD dst_unused:UNUSED_PAD src0_sel:WORD_0 src1_sel:WORD_1
    v_add_u32_sdwa v66, v66, v50 dst_sel:DWORD dst_unused:UNUSED_PAD src0_sel:WORD_0 src1_sel:WORD_1
    v_add_u32_sdwa v67, v67, v51 dst_sel:DWORD dst_unused:UNUSED_PAD src0_sel:WORD_0 src1_sel:WORD_1
    ds_read_b32 v32, v64
    ds_read_b32 v33, v65
    ds_read_b32 v34, v66
    ds_read_b32 v35, v67
    s_setprio 3
    s_waitcnt lgkmcnt(4)
    v_or_b32 v0, v2, v105
    s_nop 1
    v_xor_b32_dpp v144, v28, v0 quad_perm:[0,0,0,0] row_mask:0xf bank_mask:0xf
    v_xor_b32_dpp v145, v29, v0 quad_perm:[0,0,0,0] row_mask:0xf bank_mask:0xf
    v_xor_b32_dpp v146, v30, v0 quad_perm:[0,0,0,0] row_mask:0xf bank_mask:0xf
    v_xor_b32_dpp v147, v31, v0 quad_perm:[0,0,0,0] row_mask:0xf bank_mask:0xf
    v_xor_b32_dpp v148, v28, v0 quad_perm:[1,1,1,1] row_mask:0xf bank_mask:0xf
    s_branch K2_HOP
    .p2align 6
K2_WAIT:
    v_xor_b32_dpp v144, v28, v0 quad_perm:[0,0,0,0] row_mask:0xf bank_mask:0xf
    v_xor_b32_dpp v145, v29, v0 quad_perm:[0,0,0,0] row_mask:0xf bank_mask:0xf
    v_xor_b32_dpp v146, v30, v0 quad_perm:[0,0,0,0] row_mask:0xf bank_mask:0xf
    v_xor_b32_dpp v147, v31, v0 quad_perm:[0,0,0,0] row_mask:0xf bank_mask:0xf
    v_xor_b32_dpp v148, v28, v0 quad_perm:[1,1,1,1] row_mask:0xf bank_mask:0xf
    s_cmp_lg_u32 s3, 0
    s_cbranch_scc1 K2_SYNCED
    s_mov_b32 s54, 0
    s_mov_b64 exec, 0xffff
POLL_H:
    s_add_u32 s54, s54, 1
    s_cmp_gt_u32 s54, s52
    s_cselect_b32 s52, 0, s52
    s_cbranch_scc1 POLLED_H
    global_atomic_add v168, v173, v175, s[36:37] sc0
POLLW_H:
    s_waitcnt vmcnt(0)
    v_cmpx_ne_u32 s[56:57], 16, v168
    s_cbranch_execnz POLL_H
POLLED_H:
    s_mov_b64 exec, -1
K2_SYNCED:
    s_waitcnt lgkmcnt(0)
    s_barrier
K2_HOP:
    buffer_load_dwordx4 v[76:79], v144, s[16:19], 0 offen sc1
    buffer_load_dwordx4 v[80:83], v145, s[16:19], 0 offen sc1
    buffer_load_dwordx4 v[84:87], v146, s[16:19], 0 offen sc1
    buffer_load_dwordx4 v[88:91], v147, s[16:19], 0 offen sc1
    buffer_load_dwordx4 v[92:95], v148, s[16:19], 0 offen sc1
    s_cmp_gt_u32 s6, 5
    s_cbranch_scc1 K2_ONCE_DONE
    s_cmp_lg_u32 s6, 1
    s_cbranch_scc1 K2_HAVE_ROWS
    s_movk_i32 s90, 55
    s_max_u32 s7, s7, 6
    v_perm_b32 v68, v17, v16, v52
    v_perm_b32 v69, v17, v16, v53
    v_perm_b32 v70, v17, v16, v54
    v_perm_b32 v71, v17, v16, v55
    v_perm_b32 v72, v17, v16, v56
    v_perm_b32 v73, v17, v16, v57
    v_perm_b32 v74, v17, v16, v58
    v_perm_b32 v75, v17, v16, v59
    v_add_u32_sdwa v68, v68, v52 dst_sel:DWORD dst_unused:UNUSED_PAD src0_sel:WORD_0 src1_sel:WORD_1
    v_add_u32_sdwa v69, v69, v53 dst_sel:DWORD dst_unused:UNUSED_PAD src0_sel:WORD_0 src1_sel:WORD_1
    v_add_u32_sdwa v70, v70, v54 dst_sel:DWORD dst_unused:UNUSED_PAD src0_sel:WORD_0 src1_sel:WORD_1
    v_add_u32_sdwa v71, v71, v55 dst_sel:DWORD dst_unused:UNUSED_PAD src0_sel:WORD_0 src1_sel:WORD_1
    v_add_u32_sdwa v72, v72, v56 dst_sel:DWORD dst_unused:UNUSED_PAD src0_sel:WORD_0 src1_sel:WORD_1
    v_add_u32_sdwa v73, v73, v57 dst_sel:DWORD dst_unused:UNUSED_PAD src0_sel:WORD_0 src1_sel:WORD_1
    v_add_u32_sdwa v74, v74, v58 dst_sel:DWORD dst_unused:UNUSED_PAD src0_sel:WORD_0 src1_sel:WORD_1
    v_add_u32_sdwa v75, v75, v59 dst_sel:DWORD dst_unused:UNUSED_PAD src0_sel:WORD_0 src1_sel:WORD_1
    ds_read_b32 v36, v68
    ds_read_b32 v37, v69
    ds_read_b32 v38, v70
    ds_read_b32 v39, v71
    ds_read_b32 v40, v72
    ds_read_b32 v41, v73
    ds_read_b32 v42, v74
    ds_read_b32 v43, v75
    v_lshrrev_b32 v24, 16, v24
    v_lshrrev_b32 v25, 16, v25
    v_lshrrev_b32 v26, 16, v26
    v_lshrrev_b32 v27, 16, v27
    v_add_u32 v48, 81920, v2
    s_mov_b32 s54, 108544
    v_lshl_add_u32 v44, v24, 7, v48
    v_lshl_add_u32 v17, v24, 2, s54
    v_lshl_add_u32 v45, v25, 7, v48
    v_lshl_add_u32 v19, v25, 2, s54
    v_lshl_add_u32 v46, v26, 7, v48
    v_lshl_add_u32 v21, v26, 2, s54
    v_lshl_add_u32 v47, v27, 7, v48
    v_lshl_add_u32 v23, v27, 2, s54
    ds_read_b128 v[116:119], v44
    ds_read2st64_b32 v[16:17], v17 offset1:4
    ds_read_b128 v[120:123], v45
    ds_read2st64_b32 v[18:19], v19 offset1:4
    ds_read_b128 v[124:127], v46
    ds_read2st64_b32 v[20:21], v21 offset1:4
    ds_read_b128 v[128:131], v47
    ds_read2st64_b32 v[22:23], v23 offset1:4
    s_mov_b32 s78, 0x55555555
    s_mov_b32 s79, 0x55555555
    s_bitreplicate_b64_b32 s[80:81], s74
    s_bitreplicate_b64_b32 s[82:83], s76
    s_and_b64 s[80:81], s[80:81], s[78:79]
    s_andn2_b64 s[82:83], s[82:83], s[78:79]
    s_or_b64 s[38:39], s[80:81], s[82:83]
    s_bitreplicate_b64_b32 s[80:81], s75
    s_bitreplicate_b64_b32 s[82:83], s77
    s_and_b64 s[80:81], s[80:81], s[78:79]
    s_andn2_b64 s[82:83], s[82:83], s[78:79]
    s_or_b64 s[40:41], s[80:81], s[82:83]
    v_cmp_gt_u32 s[42:43], 64, v24
    v_cmp_gt_u32 s[44:45], 64, v25
    v_cmp_gt_u32 s[46:47], 64, v26
    v_cmp_gt_u32 s[48:49], 64, v27
    v_cmp_gt_u32 vcc, 196, v27
    v_mov_b32 v136, 2130706432
    s_waitcnt lgkmcnt(0)
    s_barrier
    v_xor_b32 v8, v16, v0
    v_mul_f32 v16, v17, v17
    v_xor_b32 v9, v18, v0
    v_mul_f32 v18, v19, v19
    v_xor_b32 v10, v20, v0
    v_mul_f32 v20, v21, v21
    v_xor_b32 v11, v22, v0
    v_mul_f32 v22, v23, v23
    v_cndmask_b32 v11, v136, v11, vcc
    s_branch K2_ONCE_DONE
K2_HAVE_ROWS:
    s_cmp_eq_u32 s6, 4
    s_cbranch_scc1 K2_SETUP
    s_cmp_eq_u32 s6, 5
    s_cbranch_scc1 K2_FRAGS
    s_lshr_b32 s54, s3, 2
    s_add_u32 s54, s54, 2
    s_cmp_lg_u32 s6, s54
    s_cbranch_scc1 K2_ONCE_DONE
    v_lshlrev_b32 v44, 16, v116
    v_and_b32 v45, 0xffff0000, v116
    v_lshlrev_b32 v46, 16, v117
    v_and_b32 v47, 0xffff0000, v117
    v_lshlrev_b32 v60, 16, v118
    v_and_b32 v61, 0xffff0000, v118
    v_lshlrev_b32 v62, 16, v119
    v_and_b32 v63, 0xffff0000, v119
    v_lshlrev_b32 v48, 16, v120
    v_and_b32 v49, 0xffff0000, v120
    v_lshlrev_b32 v50, 16, v121
    v_and_b32 v51, 0xffff0000, v121
    v_lshlrev_b32 v64, 16, v122
    v_and_b32 v65, 0xffff0000, v122
    v_lshlrev_b32 v66, 16, v123
    v_and_b32 v67, 0xffff0000, v123
    v_lshlrev_b32 v52, 16, v124
    v_and_b32 v53, 0xffff0000, v124
    v_lshlrev_b32 v54, 16, v125
    v_and_b32 v55, 0xffff0000, v125
    v_lshlrev_b32 v68, 16, v126
    v_and_b32 v69, 0xffff0000, v126
    v_lshlrev_b32 v70, 16, v127
    v_and_b32 v71, 0xffff0000, v127
    v_lshlrev_b32 v56, 16, v128
    v_and_b32 v57, 0xffff0000, v128
    v_lshlrev_b32 v58, 16, v129
    v_and_b32 v59, 0xffff0000, v129
    v_lshlrev_b32 v72, 16, v130
    v_and_b32 v73, 0xffff0000, v130
    v_lshlrev_b32 v74, 16, v131
    v_and_b32 v75, 0xffff0000, v131
    s_mul_i32 s60, 0, 0x90
    s_bitcmp1_b32 s60, 4
    s_cselect_b32 s61, 0xffff0000, s63
    s_bitcmp1_b32 s60, 5
    s_cselect_b32 s57, s61, 0
    s_cselect_b32 s61, 0, s61
    s_lshl_b32 s62, 0, 3
    v_pk_add_f32 v[148:149], v[44:45], v[46:47]
    v_pk_add_f32 v[152:153], v[48:49], v[50:51]
    v_pk_add_f32 v[156:157], v[52:53], v[54:55]
    v_pk_mul_f32 v[150:151], v[44:45], v[44:45]
    v_pk_mul_f32 v[154:155], v[48:49], v[48:49]
    v_pk_mul_f32 v[158:159], v[52:53], v[52:53]
    v_pk_fma_f32 v[150:151], v[46:47], v[46:47], v[150:151]
    v_pk_fma_f32 v[154:155], v[50:51], v[50:51], v[154:155]
    v_pk_fma_f32 v[158:159], v[54:55], v[54:55], v[158:159]
    v_pk_add_f32 v[148:149], v[148:149], v[60:61]
    v_pk_add_f32 v[152:153], v[152:153], v[64:65]
    v_pk_add_f32 v[156:157], v[156:157], v[68:69]
    v_pk_fma_f32 v[150:151], v[60:61], v[60:61], v[150:151]
    v_pk_fma_f32 v[154:155], v[64:65], v[64:65], v[154:155]
    v_pk_fma_f32 v[158:159], v[68:69], v[68:69], v[158:159]
    v_pk_add_f32 v[148:149], v[148:149], v[62:63]
    v_pk_add_f32 v[152:153], v[152:153], v[66:67]
    v_pk_add_f32 v[156:157], v[156:157], v[70:71]
    v_pk_fma_f32 v[150:151], v[62:63], v[62:63], v[150:151]
    v_pk_fma_f32 v[154:155], v[66:67], v[66:67], v[154:155]
    v_pk_fma_f32 v[158:159], v[70:71], v[70:71], v[158:159]
    v_add_f32 v148, v148, v149
    v_add_f32 v152, v152, v153
    v_add_f32 v156, v156, v157
    v_add_f32 v149, v150, v151
    v_add_f32 v153, v154, v155
    v_add_f32 v157, v158, v159
    v_add_f32_dpp v148, v148, v148 quad_perm:[1,0,3,2] row_mask:0xf bank_mask:0xf
    v_add_f32_dpp v152, v152, v152 quad_perm:[1,0,3,2] row_mask:0xf bank_mask:0xf
    v_add_f32_dpp v156, v156, v156 quad_perm:[1,0,3,2] row_mask:0xf bank_mask:0xf
    v_add_f32_dpp v149, v149, v149 quad_perm:[1,0,3,2] row_mask:0xf bank_mask:0xf
    v_add_f32_dpp v153, v153, v153 quad_perm:[1,0,3,2] row_mask:0xf bank_mask:0xf
    v_add_f32_dpp v157, v157, v157 quad_perm:[1,0,3,2] row_mask:0xf bank_mask:0xf
    v_add_f32_dpp v148, v148, v148 quad_perm:[2,3,0,1] row_mask:0xf bank_mask:0xf
    v_add_f32_dpp v152, v152, v152 quad_perm:[2,3,0,1] row_mask:0xf bank_mask:0xf
    v_add_f32_dpp v156, v156, v156 quad_perm:[2,3,0,1] row_mask:0xf bank_mask:0xf
    v_add_f32_dpp v149, v149, v149 quad_perm:[2,3,0,1] row_mask:0xf bank_mask:0xf
    v_add_f32_dpp v153, v153, v153 quad_perm:[2,3,0,1] row_mask:0xf bank_mask:0xf
    v_add_f32_dpp v157, v157, v157 quad_perm:[2,3,0,1] row_mask:0xf bank_mask:0xf
    v_add_f32_dpp v148, v148, v148 row_half_mirror row_mask:0xf bank_mask:0xf
    v_add_f32_dpp v152, v152, v152 row_half_mirror row_mask:0xf bank_mask:0xf
    v_add_f32_dpp v156, v156, v156 row_half_mirror row_mask:0xf bank_mask:0xf
    v_add_f32_dpp v149, v149, v149 row_half_mirror row_mask:0xf bank_mask:0xf
    v_add_f32_dpp v153, v153, v153 row_half_mirror row_mask:0xf bank_mask:0xf
    v_add_f32_dpp v157, v157, v157 row_half_mirror row_mask:0xf bank_mask:0xf
    v_mul_f32 v151, 0xbc800000, v148
    v_mul_f32 v155, 0xbc800000, v152
    v_mul_f32 v159, 0xbc800000, v156
    v_mov_b32 v150, 0x3727c5ac
    v_mov_b32 v154, 0x3727c5ac
    v_mov_b32 v158, 0x3727c5ac
    v_fmac_f32 v149, v151, v148
    v_fmac_f32 v153, v155, v152
    v_fmac_f32 v157, v159, v156
    v_max_f32 v149, 0, v149
    v_max_f32 v153, 0, v153
    v_max_f32 v157, 0, v157
    v_fmac_f32 v150, 0x3c800000, v149
    v_fmac_f32 v154, 0x3c800000, v153
    v_fmac_f32 v158, 0x3c800000, v157
    v_sqrt_f32 v149, v150
    v_sqrt_f32 v153, v154
    v_sqrt_f32 v157, v158
    v_cvt_pk_bf16_f32 v149, v149, v149
    v_cvt_pk_bf16_f32 v153, v153, v153
    v_cvt_pk_bf16_f32 v157, v157, v157
    v_and_b32 v150, 0xffff0000, v149
    v_and_b32 v154, 0xffff0000, v153
    v_and_b32 v158, 0xffff0000, v157
    v_rcp_f32 v150, v150
    v_rcp_f32 v154, v154
    v_rcp_f32 v158, v158
    v_mul_f32 v144, -v151, 1.0
    v_mul_f32 v145, -v155, 1.0
    v_mul_f32 v146, -v159, 1.0
    v_mul_f32 v148, v151, v150
    v_mul_f32 v152, v155, v154
    v_mul_f32 v156, v159, v158
    v_pk_fma_f32 v[44:45], v[44:45], v[150:151], v[148:149] op_sel_hi:[1,0,0]
    v_pk_fma_f32 v[48:49], v[48:49], v[154:155], v[152:153] op_sel_hi:[1,0,0]
    v_pk_fma_f32 v[52:53], v[52:53], v[158:159], v[156:157] op_sel_hi:[1,0,0]
    v_pk_fma_f32 v[46:47], v[46:47], v[150:151], v[148:149] op_sel_hi:[1,0,0]
    v_pk_fma_f32 v[50:51], v[50:51], v[154:155], v[152:153] op_sel_hi:[1,0,0]
    v_pk_fma_f32 v[54:55], v[54:55], v[158:159], v[156:157] op_sel_hi:[1,0,0]
    v_pk_fma_f32 v[60:61], v[60:61], v[150:151], v[148:149] op_sel_hi:[1,0,0]
    v_pk_fma_f32 v[64:65], v[64:65], v[154:155], v[152:153] op_sel_hi:[1,0,0]
    v_pk_fma_f32 v[68:69], v[68:69], v[158:159], v[156:157] op_sel_hi:[1,0,0]
    v_pk_fma_f32 v[62:63], v[62:63], v[150:151], v[148:149] op_sel_hi:[1,0,0]
    v_pk_fma_f32 v[66:67], v[66:67], v[154:155], v[152:153] op_sel_hi:[1,0,0]
    v_pk_fma_f32 v[70:71], v[70:71], v[158:159], v[156:157] op_sel_hi:[1,0,0]
    v_and_b32 v148, s61, v149
    v_and_b32 v152, s61, v153
    v_and_b32 v156, s61, v157
    v_and_b32 v149, s57, v149
    v_and_b32 v153, s57, v153
    v_and_b32 v157, s57, v157
    v_cvt_pk_bf16_f32 v132, v44, v45
    v_cvt_pk_bf16_f32 v136, v48, v49
    v_cvt_pk_bf16_f32 v133, v46, v47
    v_cvt_pk_bf16_f32 v137, v50, v51
    v_cvt_pk_bf16_f32 v134, v60, v61
    v_cvt_pk_bf16_f32 v138, v64, v65
    v_cvt_pk_bf16_f32 v135, v62, v63
    v_cvt_pk_bf16_f32 v139, v66, v67
    s_lshr_b32 s54, s62, 1
    s_set_gpr_idx_on s54, gpr_idx(DST)
    v_cvt_pk_bf16_f32 v100, v52, v53
    v_cvt_pk_bf16_f32 v101, v54, v55
    v_cvt_pk_bf16_f32 v102, v68, v69
    v_cvt_pk_bf16_f32 v103, v70, v71
    s_set_gpr_idx_off
    v_xor_b32 v3, s60, v4
    v_add_u32 v151, s62, v5
    ds_write_b128 v3, v[132:135]
    v_lshrrev_b32 v150, 1, v151
    v_add_u32 v150, 82432, v150
    ds_write_b128 v3, v[136:139] offset:8192
    s_mov_b64 exec, s[58:59]
    ds_write_b64 v151, v[148:149] offset:0
    ds_write_b32 v150, v144 offset:0
    ds_write_b64 v151, v[152:153] offset:512
    ds_write_b32 v150, v145 offset:256
    ds_write_b64 v151, v[156:157] offset:1024
    ds_write_b32 v150, v146 offset:512
    s_mov_b64 exec, -1
    s_cmp_lg_u32 s3, 7
    s_cbranch_scc1 TOK_DONE_X
    v_pk_add_f32 v[152:153], v[56:57], v[58:59]
    v_pk_mul_f32 v[154:155], v[56:57], v[56:57]
    v_pk_fma_f32 v[154:155], v[58:59], v[58:59], v[154:155]
    v_pk_add_f32 v[152:153], v[152:153], v[72:73]
    v_pk_fma_f32 v[154:155], v[72:73], v[72:73], v[154:155]
    v_pk_add_f32 v[152:153], v[152:153], v[74:75]
    v_pk_fma_f32 v[154:155], v[74:75], v[74:75], v[154:155]
    v_add_f32 v152, v152, v153
    v_add_f32 v153, v154, v155
    s_nop 0
    v_add_f32_dpp v152, v152, v152 quad_perm:[1,0,3,2] row_mask:0xf bank_mask:0xf
    v_add_f32_dpp v153, v153, v153 quad_perm:[1,0,3,2] row_mask:0xf bank_mask:0xf
    s_nop 0
    v_add_f32_dpp v152, v152, v152 quad_perm:[2,3,0,1] row_mask:0xf bank_mask:0xf
    v_add_f32_dpp v153, v153, v153 quad_perm:[2,3,0,1] row_mask:0xf bank_mask:0xf
    s_nop 0
    v_add_f32_dpp v152, v152, v152 row_half_mirror row_mask:0xf bank_mask:0xf
    v_add_f32_dpp v153, v153, v153 row_half_mirror row_mask:0xf bank_mask:0xf
    v_mul_f32 v155, 0xbc800000, v152
    v_mov_b32 v154, 0x3727c5ac
    v_fmac_f32 v153, v155, v152
    v_max_f32 v153, 0, v153
    v_fmac_f32 v154, 0x3c800000, v153
    v_sqrt_f32 v153, v154
    s_nop 0
    v_cvt_pk_bf16_f32 v153, v153, v153
    v_and_b32 v154, 0xffff0000, v153
    v_rcp_f32 v154, v154
    v_mul_f32 v144, -v155, 1.0
    v_mul_f32 v152, v155, v154
    v_pk_fma_f32 v[56:57], v[56:57], v[154:155], v[152:153] op_sel_hi:[1,0,0]
    v_pk_fma_f32 v[58:59], v[58:59], v[154:155], v[152:153] op_sel_hi:[1,0,0]
    v_pk_fma_f32 v[72:73], v[72:73], v[154:155], v[152:153] op_sel_hi:[1,0,0]
    v_pk_fma_f32 v[74:75], v[74:75], v[154:155], v[152:153] op_sel_hi:[1,0,0]
    v_and_b32 v152, s61, v153
    v_and_b32 v153, s57, v153
    v_cvt_pk_bf16_f32 v140, v56, v57
    v_cvt_pk_bf16_f32 v141, v58, v59
    v_cvt_pk_bf16_f32 v142, v72, v73
    v_cvt_pk_bf16_f32 v143, v74, v75
    ds_write_b128 v3, v[140:143] offset:16384
    s_mov_b64 exec, s[58:59]
    ds_write_b64 v151, v[152:153] offset:1536
    ds_write_b32 v150, v144 offset:768
    s_mov_b64 exec, -1
TOK_DONE_X:
    s_branch K2_ONCE_DONE
K2_SETUP:
    v_and_b32 v140, 15, v1
    v_lshrrev_b32 v141, 4, v1
    s_lshl_b32 s56, s3, 14
    v_bfe_u32 v143, v1, 3, 1
    v_mul_u32_u24 v143, 0x70, v143
    v_xor_b32 v143, v143, v2
    v_lshl_or_b32 v143, v140, 7, v143
    v_or_b32 v143, s56, v143
    v_lshlrev_b32 v144, 4, v141
    v_xor_b32 v176, v143, v144
    v_xor_b32 v177, 64, v176
    v_xor_b32 v178, 0x470, v176
    v_xor_b32 v179, 64, v178
    v_and_b32 v144, 1, v141
    v_lshrrev_b32 v142, 1, v141
    v_lshl_or_b32 v144, v144, 1, v142
    v_lshlrev_b32 v144, 4, v144
    v_xor_b32 v184, v143, v144
    v_xor_b32 v185, 64, v184
    v_lshlrev_b32 v143, 1, v2
    v_cmp_gt_u32 s[56:57], 8, v140
    v_mov_b32 v145, 2130706432
    ds_bpermute_b32 v12, v143, v24
    ds_bpermute_b32 v13, v143, v25
    ds_bpermute_b32 v14, v143, v26
    ds_bpermute_b32 v15, v143, v27
    s_lshl_b32 s54, s5, 7
    v_add_u32 v144, s54, v144
    s_waitcnt lgkmcnt(0)
    v_cmp_gt_u32 vcc, 196, v15
    v_lshl_add_u32 v12, v12, 7, v144
    v_cndmask_b32 v12, v145, v12, s[56:57]
    v_lshl_add_u32 v13, v13, 7, v144
    v_cndmask_b32 v13, v145, v13, s[56:57]
    v_lshl_add_u32 v14, v14, 7, v144
    v_cndmask_b32 v14, v145, v14, s[56:57]
    v_lshl_add_u32 v15, v15, 7, v144
    s_and_b64 s[56:57], s[56:57], vcc
    v_cndmask_b32 v15, v145, v15, s[56:57]
    s_lshl_b32 s56, s3, 14
    v_lshrrev_b32 v143, 2, v1
    v_and_b32 v144, 7, v143
    v_bfe_u32 v145, v1, 1, 1
    v_xor_b32 v144, v144, v145
    v_mul_u32_u24 v145, 7, v142
    v_xor_b32 v144, v144, v145
    v_lshlrev_b32 v144, 4, v144
    v_lshl_or_b32 v144, v143, 7, v144
    v_and_b32 v145, 1, v1
    v_lshl_or_b32 v144, v145, 3, v144
    v_or_b32 v180, s56, v144
    v_xor_b32 v181, 32, v180
    v_xor_b32 v182, 64, v180
    v_xor_b32 v183, 0x60, v180
    s_mul_i32 s56, s3, 1536
    s_add_u32 s56, s56, 139264
    v_lshrrev_b32 v144, 2, v140
    v_cmp_eq_u32 vcc, v144, v141
    v_lshl_add_u32 v143, v140, 3, s56
    v_mov_b32 v145, 196608
    v_lshrrev_b32 v171, 1, v143
    v_add_u32 v171, 82432, v171
    s_lshl_b32 s56, s3, 6
    v_cndmask_b32 v186, v145, v143, vcc
    s_add_u32 s56, s56, 158464
    v_lshlrev_b32 v143, 5, v142
    v_lshl_add_u32 v143, v140, 1, v143
    v_add_u32 v187, s56, v143
    v_lshl_add_u32 v143, v141, 3, s56
    v_sub_u32 v144, v140, v142
    v_cmp_eq_u32 vcc, 0, v144
    s_nop 1
    v_cndmask_b32 v188, v145, v143, vcc
    v_cmp_eq_u32 vcc, 2, v144
    s_nop 1
    v_cndmask_b32 v189, v145, v143, vcc
    v_cmp_eq_u32 vcc, 4, v144
    s_nop 1
    v_cndmask_b32 v190, v145, v143, vcc
    v_cmp_eq_u32 vcc, 6, v144
    s_nop 1
    v_cndmask_b32 v191, v145, v143, vcc
    v_mov_b32 v169, v4
    v_mov_b32 v170, 0x36a1369a
    s_branch K2_ONCE_DONE
K2_FRAGS:
    v_lshrrev_b32 v144, 3, v1
    v_lshl_add_u32 v144, v144, 10, v2
    v_lshlrev_b32 v145, 4, v1
    v_add_u32 v145, 158976, v145
    v_add_u32 v146, 65536, v144
    ds_read_b128 v[192:195], v144 offset:896
    ds_read_b128 v[196:199], v144 offset:9088
    ds_read_b128 v[200:203], v144 offset:17280
    ds_read_b128 v[204:207], v144 offset:25472
    ds_read_b128 v[208:211], v144 offset:33664
    ds_read_b128 v[212:215], v144 offset:41856
    ds_read_b128 v[216:219], v144 offset:50048
    ds_read_b128 v[220:223], v144 offset:58240
    ds_read_b128 v[224:227], v146 offset:896
    ds_read_b128 v[228:231], v146 offset:9088
    ds_read_b128 v[232:235], v146 offset:17280
    ds_read_b128 v[236:239], v146 offset:25472
    ds_read_b128 v[240:243], v146 offset:33664
    ds_read_b128 v[244:247], v146 offset:41856
    ds_read_b128 v[248:251], v146 offset:50048
    ds_read_b128 v[252:255], v146 offset:58240
    ds_read_b128 v[160:163], v145 offset:0
    ds_read_b128 v[164:167], v145 offset:1024
    s_mov_b32 s70, 0xaaaaaaaa
    s_mov_b32 s71, 0xaaaaaaaa
    s_mov_b32 s72, 0xcccccccc
    s_mov_b32 s73, 0xcccccccc
    s_mov_b32 s74, 0xf0f0f0f0
    s_mov_b32 s75, 0xf0f0f0f0
    s_mov_b32 s76, 0xff00ff00
    s_mov_b32 s77, 0xff00ff00
    s_mov_b32 s78, 0
    s_mov_b32 s79, -1
    s_mov_b32 s28, s12
    s_mov_b32 s29, s13
    s_mov_b32 s64, 0x00ff00ff
    s_mov_b32 s65, 0xff00ff00
    s_mov_b32 s66, s53
    s_mov_b32 s67, 0x3bf5fdf0
    s_mov_b32 s68, 0
K2_ONCE_DONE:
    v_mov_b32 v148, 2130706432
    v_xor_b32 v152, 0x2000, v8
    v_xor_b32 v153, 0x2000, v9
    v_xor_b32 v154, 0x2000, v10
    v_xor_b32 v155, 0x2000, v11
    v_cndmask_b32 v152, v148, v152, s[42:43]
    v_cndmask_b32 v153, v148, v153, s[44:45]
    v_cndmask_b32 v154, v148, v154, s[46:47]
    v_cndmask_b32 v155, v148, v155, s[48:49]
    v_mov_b32 v44, 0
    v_mov_b32 v45, 0
    v_mov_b32 v46, 0
    v_mov_b32 v47, 0
    v_mov_b32 v48, 0
    v_mov_b32 v49, 0
    v_mov_b32 v50, 0
    v_mov_b32 v51, 0
    v_mov_b32 v52, 0
    v_mov_b32 v53, 0
    v_mov_b32 v54, 0
    v_mov_b32 v55, 0
    v_mov_b32 v56, 0
    v_mov_b32 v57, 0
    v_mov_b32 v58, 0
    v_mov_b32 v59, 0
    v_mov_b32 v60, 0
    v_mov_b32 v61, 0
    v_mov_b32 v62, 0
    v_mov_b32 v63, 0
    v_mov_b32 v64, 0
    v_mov_b32 v65, 0
    v_mov_b32 v66, 0
    v_mov_b32 v67, 0
    v_mov_b32 v68, 0
    v_mov_b32 v69, 0
    v_mov_b32 v70, 0
    v_mov_b32 v71, 0
    v_mov_b32 v72, 0
    v_mov_b32 v73, 0
    v_mov_b32 v74, 0
    v_mov_b32 v75, 0
    s_cmp_lg_u32 s51, 0
    s_cbranch_scc1 K2_SLOW
    s_cmp_eq_u32 s6, 7
    s_cselect_b32 s54, 136, 0
    s_cmp_gt_u32 s7, s90
    s_cselect_b32 s54, -1, s54
    s_bitcmp1_b32 s54, s3
    s_cbranch_scc1 K2_DEEP
    s_lshl_b64 s[84:85], s[38:39], 10
    s_lshl_b64 s[86:87], s[40:41], 10
    s_lshr_b32 s54, s39, 22
    s_lshr_b32 s88, s41, 22
    s_or_b32 s86, s86, s54
    s_mov_b32 s89, s7
    s_mov_b32 s91, 0
    v_mov_b32 v140, v28
    v_mov_b32 v141, v29
    v_mov_b32 v142, v30
    v_mov_b32 v143, v31
    s_branch HN_4
    .p2align 6
HL:
    s_add_u32 s91, s91, 4
    s_set_gpr_idx_on s91, gpr_idx(SRC0)
    v_mov_b32 v140, v28
    v_mov_b32 v141, v29
    v_mov_b32 v142, v30
    v_mov_b32 v143, v31
    s_set_gpr_idx_off
    s_mov_b32 s84, s85
    s_mov_b32 s85, s86
    s_mov_b32 s86, s87
    s_mov_b32 s87, s88
    s_sub_i32 s89, s89, 16
    s_cmp_gt_i32 s89, 0
    s_cbranch_scc0 HK_0
    v_xor_b32_dpp v3, v140, v0 quad_perm:[0,0,0,0] row_mask:0xf bank_mask:0xf
    s_bfe_u32 s54, s84, 0x20000
    s_lshl_b32 s54, s54, 2
    s_set_gpr_idx_on s54, gpr_idx(SRC2,DST)
    s_waitcnt vmcnt(4)
    buffer_load_dwordx4 v[76:79], v3, s[16:19], 0 offen sc1
    v_mfma_f32_4x4x4_16b_bf16 v[44:47], v[6:7], v[88:89], v[44:47]
    v_mfma_f32_4x4x4_16b_bf16 v[60:63], v[6:7], v[90:91], v[60:63]
    s_set_gpr_idx_off
HN_0:
    s_cmp_gt_i32 s89, 1
    s_cbranch_scc0 HK_1
    v_xor_b32_dpp v3, v141, v0 quad_perm:[0,0,0,0] row_mask:0xf bank_mask:0xf
    s_bfe_u32 s54, s84, 0x20002
    s_lshl_b32 s54, s54, 2
    s_set_gpr_idx_on s54, gpr_idx(SRC2,DST)
    s_waitcnt vmcnt(4)
    buffer_load_dwordx4 v[80:83], v3, s[16:19], 0 offen sc1
    v_mfma_f32_4x4x4_16b_bf16 v[44:47], v[6:7], v[92:93], v[44:47]
    v_mfma_f32_4x4x4_16b_bf16 v[60:63], v[6:7], v[94:95], v[60:63]
    s_set_gpr_idx_off
HN_1:
    s_cmp_gt_i32 s89, 2
    s_cbranch_scc0 HK_2
    v_xor_b32_dpp v3, v142, v0 quad_perm:[0,0,0,0] row_mask:0xf bank_mask:0xf
    s_bfe_u32 s54, s84, 0x20004
    s_lshl_b32 s54, s54, 2
    s_set_gpr_idx_on s54, gpr_idx(SRC2,DST)
    s_waitcnt vmcnt(4)
    buffer_load_dwordx4 v[84:87], v3, s[16:19], 0 offen sc1
    v_mfma_f32_4x4x4_16b_bf16 v[44:47], v[6:7], v[96:97], v[44:47]
    v_mfma_f32_4x4x4_16b_bf16 v[60:63], v[6:7], v[98:99], v[60:63]
    s_set_gpr_idx_off
HN_2:
    s_cmp_gt_i32 s89, 3
    s_cbranch_scc0 HK_3
    v_xor_b32_dpp v3, v143, v0 quad_perm:[0,0,0,0] row_mask:0xf bank_mask:0xf
    s_bfe_u32 s54, s84, 0x20006
    s_lshl_b32 s54, s54, 2
    s_set_gpr_idx_on s54, gpr_idx(SRC2,DST)
    s_waitcnt vmcnt(4)
    buffer_load_dwordx4 v[88:91], v3, s[16:19], 0 offen sc1
    v_mfma_f32_4x4x4_16b_bf16 v[44:47], v[6:7], v[132:133], v[44:47]
    v_mfma_f32_4x4x4_16b_bf16 v[60:63], v[6:7], v[134:135], v[60:63]
    s_set_gpr_idx_off
HN_3:
    s_cmp_gt_i32 s89, 4
    s_cbranch_scc0 HK_4
    v_xor_b32_dpp v3, v140, v0 quad_perm:[1,1,1,1] row_mask:0xf bank_mask:0xf
    s_bfe_u32 s54, s84, 0x20008
    s_lshl_b32 s54, s54, 2
    s_set_gpr_idx_on s54, gpr_idx(SRC2,DST)
    s_waitcnt vmcnt(4)
    buffer_load_dwordx4 v[92:95], v3, s[16:19], 0 offen sc1
    v_mfma_f32_4x4x4_16b_bf16 v[44:47], v[6:7], v[136:137], v[44:47]
    v_mfma_f32_4x4x4_16b_bf16 v[60:63], v[6:7], v[138:139], v[60:63]
    s_set_gpr_idx_off
HN_4:
    s_cmp_gt_i32 s89, 5
    s_cbranch_scc0 HK_5
    v_xor_b32_dpp v3, v141, v0 quad_perm:[1,1,1,1] row_mask:0xf bank_mask:0xf
    s_bfe_u32 s54, s84, 0x2000a
    s_lshl_b32 s54, s54, 2
    s_set_gpr_idx_on s54, gpr_idx(SRC2,DST)
    s_waitcnt vmcnt(4)
    buffer_load_dwordx4 v[96:99], v3, s[16:19], 0 offen sc1
    v_mfma_f32_4x4x4_16b_bf16 v[44:47], v[6:7], v[76:77], v[44:47]
    v_mfma_f32_4x4x4_16b_bf16 v[60:63], v[6:7], v[78:79], v[60:63]
    s_set_gpr_idx_off
HN_5:
    s_cmp_gt_i32 s89, 6
    s_cbranch_scc0 HK_6
    v_xor_b32_dpp v3, v142, v0 quad_perm:[1,1,1,1] row_mask:0xf bank_mask:0xf
    s_bfe_u32 s54, s84, 0x2000c
    s_lshl_b32 s54, s54, 2
    s_set_gpr_idx_on s54, gpr_idx(SRC2,DST)
    s_waitcnt vmcnt(4)
    buffer_load_dwordx4 v[132:135], v3, s[16:19], 0 offen sc1
    v_mfma_f32_4x4x4_16b_bf16 v[44:47], v[6:7], v[80:81], v[44:47]
    v_mfma_f32_4x4x4_16b_bf16 v[60:63], v[6:7], v[82:83], v[60:63]
    s_set_gpr_idx_off
HN_6:
    s_cmp_gt_i32 s89, 7
    s_cbranch_scc0 HK_7
    v_xor_b32_dpp v3, v143, v0 quad_perm:[1,1,1,1] row_mask:0xf bank_mask:0xf
    s_bfe_u32 s54, s84, 0x2000e
    s_lshl_b32 s54, s54, 2
    s_set_gpr_idx_on s54, gpr_idx(SRC2,DST)
    s_waitcnt vmcnt(4)
    buffer_load_dwordx4 v[136:139], v3, s[16:19], 0 offen sc1
    v_mfma_f32_4x4x4_16b_bf16 v[44:47], v[6:7], v[84:85], v[44:47]
    v_mfma_f32_4x4x4_16b_bf16 v[60:63], v[6:7], v[86:87], v[60:63]
    s_set_gpr_idx_off
HN_7:
    s_cmp_gt_i32 s89, 8
    s_cbranch_scc0 HK_8
    v_xor_b32_dpp v3, v140, v0 quad_perm:[2,2,2,2] row_mask:0xf bank_mask:0xf
    s_bfe_u32 s54, s84, 0x20010
    s_lshl_b32 s54, s54, 2
    s_set_gpr_idx_on s54, gpr_idx(SRC2,DST)
    s_waitcnt vmcnt(4)
    buffer_load_dwordx4 v[76:79], v3, s[16:19], 0 offen sc1
    v_mfma_f32_4x4x4_16b_bf16 v[44:47], v[6:7], v[88:89], v[44:47]
    v_mfma_f32_4x4x4_16b_bf16 v[60:63], v[6:7], v[90:91], v[60:63]
    s_set_gpr_idx_off
HN_8:
    s_cmp_gt_i32 s89, 9
    s_cbranch_scc0 HK_9
    v_xor_b32_dpp v3, v141, v0 quad_perm:[2,2,2,2] row_mask:0xf bank_mask:0xf
    s_bfe_u32 s54, s84, 0x20012
    s_lshl_b32 s54, s54, 2
    s_set_gpr_idx_on s54, gpr_idx(SRC2,DST)
    s_waitcnt vmcnt(4)
    buffer_load_dwordx4 v[80:83], v3, s[16:19], 0 offen sc1
    v_mfma_f32_4x4x4_16b_bf16 v[44:47], v[6:7], v[92:93], v[44:47]
    v_mfma_f32_4x4x4_16b_bf16 v[60:63], v[6:7], v[94:95], v[60:63]
    s_set_gpr_idx_off
HN_9:
    s_cmp_gt_i32 s89, 10
    s_cbranch_scc0 HK_10
    v_xor_b32_dpp v3, v142, v0 quad_perm:[2,2,2,2] row_mask:0xf bank_mask:0xf
    s_bfe_u32 s54, s84, 0x20014
    s_lshl_b32 s54, s54, 2
    s_set_gpr_idx_on s54, gpr_idx(SRC2,DST)
    s_waitcnt vmcnt(4)
    buffer_load_dwordx4 v[84:87], v3, s[16:19], 0 offen sc1
    v_mfma_f32_4x4x4_16b_bf16 v[44:47], v[6:7], v[96:97], v[44:47]
    v_mfma_f32_4x4x4_16b_bf16 v[60:63], v[6:7], v[98:99], v[60:63]
    s_set_gpr_idx_off
HN_10:
    s_cmp_gt_i32 s89, 11
    s_cbranch_scc0 HK_11
    v_xor_b32_dpp v3, v143, v0 quad_perm:[2,2,2,2] row_mask:0xf bank_mask:0xf
    s_bfe_u32 s54, s84, 0x20016
    s_lshl_b32 s54, s54, 2
    s_set_gpr_idx_on s54, gpr_idx(SRC2,DST)
    s_waitcnt vmcnt(4)
    buffer_load_dwordx4 v[88:91], v3, s[16:19], 0 offen sc1
    v_mfma_f32_4x4x4_16b_bf16 v[44:47], v[6:7], v[132:133], v[44:47]
    v_mfma_f32_4x4x4_16b_bf16 v[60:63], v[6:7], v[134:135], v[60:63]
    s_set_gpr_idx_off
HN_11:
    s_cmp_gt_i32 s89, 12
    s_cbranch_scc0 HK_12
    v_xor_b32_dpp v3, v140, v0 quad_perm:[3,3,3,3] row_mask:0xf bank_mask:0xf
    s_bfe_u32 s54, s84, 0x20018
    s_lshl_b32 s54, s54, 2
    s_set_gpr_idx_on s54, gpr_idx(SRC2,DST)
    s_waitcnt vmcnt(4)
    buffer_load_dwordx4 v[92:95], v3, s[16:19], 0 offen sc1
    v_mfma_f32_4x4x4_16b_bf16 v[44:47], v[6:7], v[136:137], v[44:47]
    v_mfma_f32_4x4x4_16b_bf16 v[60:63], v[6:7], v[138:139], v[60:63]
    s_set_gpr_idx_off
HN_12:
    s_cmp_gt_i32 s89, 13
    s_cbranch_scc0 HK_13
    v_xor_b32_dpp v3, v141, v0 quad_perm:[3,3,3,3] row_mask:0xf bank_mask:0xf
    s_bfe_u32 s54, s84, 0x2001a
    s_lshl_b32 s54, s54, 2
    s_set_gpr_idx_on s54, gpr_idx(SRC2,DST)
    s_waitcnt vmcnt(4)
    buffer_load_dwordx4 v[96:99], v3, s[16:19], 0 offen sc1
    v_mfma_f32_4x4x4_16b_bf16 v[44:47], v[6:7], v[76:77], v[44:47]
    v_mfma_f32_4x4x4_16b_bf16 v[60:63], v[6:7], v[78:79], v[60:63]
    s_set_gpr_idx_off
HN_13:
    s_cmp_gt_i32 s89, 14
    s_cbranch_scc0 HK_14
    v_xor_b32_dpp v3, v142, v0 quad_perm:[3,3,3,3] row_mask:0xf bank_mask:0xf
    s_bfe_u32 s54, s84, 0x2001c
    s_lshl_b32 s54, s54, 2
    s_set_gpr_idx_on s54, gpr_idx(SRC2,DST)
    s_waitcnt vmcnt(4)
    buffer_load_dwordx4 v[132:135], v3, s[16:19], 0 offen sc1
    v_mfma_f32_4x4x4_16b_bf16 v[44:47], v[6:7], v[80:81], v[44:47]
    v_mfma_f32_4x4x4_16b_bf16 v[60:63], v[6:7], v[82:83], v[60:63]
    s_set_gpr_idx_off
HN_14:
    s_cmp_gt_i32 s89, 15
    s_cbranch_scc0 HK_15
    v_xor_b32_dpp v3, v143, v0 quad_perm:[3,3,3,3] row_mask:0xf bank_mask:0xf
    s_bfe_u32 s54, s84, 0x2001e
    s_lshl_b32 s54, s54, 2
    s_set_gpr_idx_on s54, gpr_idx(SRC2,DST)
    s_waitcnt vmcnt(4)
    buffer_load_dwordx4 v[136:139], v3, s[16:19], 0 offen sc1
    v_mfma_f32_4x4x4_16b_bf16 v[44:47], v[6:7], v[84:85], v[44:47]
    v_mfma_f32_4x4x4_16b_bf16 v[60:63], v[6:7], v[86:87], v[60:63]
    s_set_gpr_idx_off
HN_15:
    s_branch HL
HK_8:
    s_lshr_b64 s[84:85], s[84:85], 14
    s_branch HT_0
HK_9:
    s_lshr_b64 s[84:85], s[84:85], 16
    s_branch HT_1
HK_10:
    s_lshr_b64 s[84:85], s[84:85], 18
    s_branch HT_2
HK_11:
    s_lshr_b64 s[84:85], s[84:85], 20
    s_branch HT_3
HK_12:
    s_lshr_b64 s[84:85], s[84:85], 22
    s_branch HT_4
HK_13:
    s_lshr_b64 s[84:85], s[84:85], 24
    s_branch HT_5
HK_14:
    s_lshr_b64 s[84:85], s[84:85], 26
    s_branch HT_6
HK_15:
    s_lshr_b64 s[84:85], s[84:85], 28
    s_branch HT_7
HK_0:
    s_lshl_b32 s84, s84, 2
HT_0:
    s_and_b32 s54, s84, 12
    s_set_gpr_idx_on s54, gpr_idx(SRC2,DST)
    s_lshr_b32 s84, s84, 2
    s_waitcnt vmcnt(4)
    v_mfma_f32_4x4x4_16b_bf16 v[44:47], v[6:7], v[88:89], v[44:47]
    v_mfma_f32_4x4x4_16b_bf16 v[60:63], v[6:7], v[90:91], v[60:63]
    s_and_b32 s54, s84, 12
    s_set_gpr_idx_on s54, gpr_idx(SRC2,DST)
    s_lshr_b32 s84, s84, 2
    s_waitcnt vmcnt(3)
    v_mfma_f32_4x4x4_16b_bf16 v[44:47], v[6:7], v[92:93], v[44:47]
    v_mfma_f32_4x4x4_16b_bf16 v[60:63], v[6:7], v[94:95], v[60:63]
    s_and_b32 s54, s84, 12
    s_set_gpr_idx_on s54, gpr_idx(SRC2,DST)
    s_lshr_b32 s84, s84, 2
    s_waitcnt vmcnt(2)
    v_mfma_f32_4x4x4_16b_bf16 v[44:47], v[6:7], v[96:97], v[44:47]
    v_mfma_f32_4x4x4_16b_bf16 v[60:63], v[6:7], v[98:99], v[60:63]
    s_and_b32 s54, s84, 12
    s_set_gpr_idx_on s54, gpr_idx(SRC2,DST)
    s_lshr_b32 s84, s84, 2
    s_waitcnt vmcnt(1)
    v_mfma_f32_4x4x4_16b_bf16 v[44:47], v[6:7], v[132:133], v[44:47]
    v_mfma_f32_4x4x4_16b_bf16 v[60:63], v[6:7], v[134:135], v[60:63]
    s_and_b32 s54, s84, 12
    s_set_gpr_idx_on s54, gpr_idx(SRC2,DST)
    s_cmp_eq_u32 s6, 7
    s_waitcnt vmcnt(0)
    v_mfma_f32_4x4x4_16b_bf16 v[44:47], v[6:7], v[136:137], v[44:47]
    v_mfma_f32_4x4x4_16b_bf16 v[60:63], v[6:7], v[138:139], v[60:63]
    s_set_gpr_idx_off
    s_branch K2_FIN2
HK_1:
    s_lshr_b32 s84, s84, 0
HT_1:
    s_and_b32 s54, s84, 12
    s_set_gpr_idx_on s54, gpr_idx(SRC2,DST)
    s_lshr_b32 s84, s84, 2
    s_waitcnt vmcnt(4)
    v_mfma_f32_4x4x4_16b_bf16 v[44:47], v[6:7], v[92:93], v[44:47]
    v_mfma_f32_4x4x4_16b_bf16 v[60:63], v[6:7], v[94:95], v[60:63]
    s_and_b32 s54, s84, 12
    s_set_gpr_idx_on s54, gpr_idx(SRC2,DST)
    s_lshr_b32 s84, s84, 2
    s_waitcnt vmcnt(3)
    v_mfma_f32_4x4x4_16b_bf16 v[44:47], v[6:7], v[96:97], v[44:47]
    v_mfma_f32_4x4x4_16b_bf16 v[60:63], v[6:7], v[98:99], v[60:63]
    s_and_b32 s54, s84, 12
    s_set_gpr_idx_on s54, gpr_idx(SRC2,DST)
    s_lshr_b32 s84, s84, 2
    s_waitcnt vmcnt(2)
    v_mfma_f32_4x4x4_16b_bf16 v[44:47], v[6:7], v[132:133], v[44:47]
    v_mfma_f32_4x4x4_16b_bf16 v[60:63], v[6:7], v[134:135], v[60:63]
    s_and_b32 s54, s84, 12
    s_set_gpr_idx_on s54, gpr_idx(SRC2,DST)
    s_lshr_b32 s84, s84, 2
    s_waitcnt vmcnt(1)
    v_mfma_f32_4x4x4_16b_bf16 v[44:47], v[6:7], v[136:137], v[44:47]
    v_mfma_f32_4x4x4_16b_bf16 v[60:63], v[6:7], v[138:139], v[60:63]
    s_and_b32 s54, s84, 12
    s_set_gpr_idx_on s54, gpr_idx(SRC2,DST)
    s_cmp_eq_u32 s6, 7
    s_waitcnt vmcnt(0)
    v_mfma_f32_4x4x4_16b_bf16 v[44:47], v[6:7], v[76:77], v[44:47]
    v_mfma_f32_4x4x4_16b_bf16 v[60:63], v[6:7], v[78:79], v[60:63]
    s_set_gpr_idx_off
    s_branch K2_FIN2
HK_2:
    s_lshr_b32 s84, s84, 2
HT_2:
    s_and_b32 s54, s84, 12
    s_set_gpr_idx_on s54, gpr_idx(SRC2,DST)
    s_lshr_b32 s84, s84, 2
    s_waitcnt vmcnt(4)
    v_mfma_f32_4x4x4_16b_bf16 v[44:47], v[6:7], v[96:97], v[44:47]
    v_mfma_f32_4x4x4_16b_bf16 v[60:63], v[6:7], v[98:99], v[60:63]
    s_and_b32 s54, s84, 12
    s_set_gpr_idx_on s54, gpr_idx(SRC2,DST)
    s_lshr_b32 s84, s84, 2
    s_waitcnt vmcnt(3)
    v_mfma_f32_4x4x4_16b_bf16 v[44:47], v[6:7], v[132:133], v[44:47]
    v_mfma_f32_4x4x4_16b_bf16 v[60:63], v[6:7], v[134:135], v[60:63]
    s_and_b32 s54, s84, 12
    s_set_gpr_idx_on s54, gpr_idx(SRC2,DST)
    s_lshr_b32 s84, s84, 2
    s_waitcnt vmcnt(2)
    v_mfma_f32_4x4x4_16b_bf16 v[44:47], v[6:7], v[136:137], v[44:47]
    v_mfma_f32_4x4x4_16b_bf16 v[60:63], v[6:7], v[138:139], v[60:63]
    s_and_b32 s54, s84, 12
    s_set_gpr_idx_on s54, gpr_idx(SRC2,DST)
    s_lshr_b32 s84, s84, 2
    s_waitcnt vmcnt(1)
    v_mfma_f32_4x4x4_16b_bf16 v[44:47], v[6:7], v[76:77], v[44:47]
    v_mfma_f32_4x4x4_16b_bf16 v[60:63], v[6:7], v[78:79], v[60:63]
    s_and_b32 s54, s84, 12
    s_set_gpr_idx_on s54, gpr_idx(SRC2,DST)
    s_cmp_eq_u32 s6, 7
    s_waitcnt vmcnt(0)
    v_mfma_f32_4x4x4_16b_bf16 v[44:47], v[6:7], v[80:81], v[44:47]
    v_mfma_f32_4x4x4_16b_bf16 v[60:63], v[6:7], v[82:83], v[60:63]
    s_set_gpr_idx_off
    s_branch K2_FIN2
HK_3:
    s_lshr_b32 s84, s84, 4
HT_3:
    s_and_b32 s54, s84, 12
    s_set_gpr_idx_on s54, gpr_idx(SRC2,DST)
    s_lshr_b32 s84, s84, 2
    s_waitcnt vmcnt(4)
    v_mfma_f32_4x4x4_16b_bf16 v[44:47], v[6:7], v[132:133], v[44:47]
    v_mfma_f32_4x4x4_16b_bf16 v[60:63], v[6:7], v[134:135], v[60:63]
    s_and_b32 s54, s84, 12
    s_set_gpr_idx_on s54, gpr_idx(SRC2,DST)
    s_lshr_b32 s84, s84, 2
    s_waitcnt vmcnt(3)
    v_mfma_f32_4x4x4_16b_bf16 v[44:47], v[6:7], v[136:137], v[44:47]
    v_mfma_f32_4x4x4_16b_bf16 v[60:63], v[6:7], v[138:139], v[60:63]
    s_and_b32 s54, s84, 12
    s_set_gpr_idx_on s54, gpr_idx(SRC2,DST)
    s_lshr_b32 s84, s84, 2
    s_waitcnt vmcnt(2)
    v_mfma_f32_4x4x4_16b_bf16 v[44:47], v[6:7], v[76:77], v[44:47]
    v_mfma_f32_4x4x4_16b_bf16 v[60:63], v[6:7], v[78:79], v[60:63]
    s_and_b32 s54, s84, 12
    s_set_gpr_idx_on s54, gpr_idx(SRC2,DST)
    s_lshr_b32 s84, s84, 2
    s_waitcnt vmcnt(1)
    v_mfma_f32_4x4x4_16b_bf16 v[44:47], v[6:7], v[80:81], v[44:47]
    v_mfma_f32_4x4x4_16b_bf16 v[60:63], v[6:7], v[82:83], v[60:63]
    s_and_b32 s54, s84, 12
    s_set_gpr_idx_on s54, gpr_idx(SRC2,DST)
    s_cmp_eq_u32 s6, 7
    s_waitcnt vmcnt(0)
    v_mfma_f32_4x4x4_16b_bf16 v[44:47], v[6:7], v[84:85], v[44:47]
    v_mfma_f32_4x4x4_16b_bf16 v[60:63], v[6:7], v[86:87], v[60:63]
    s_set_gpr_idx_off
    s_branch K2_FIN2
HK_4:
    s_lshr_b32 s84, s84, 6
HT_4:
    s_and_b32 s54, s84, 12
    s_set_gpr_idx_on s54, gpr_idx(SRC2,DST)
    s_lshr_b32 s84, s84, 2
    s_waitcnt vmcnt(4)
    v_mfma_f32_4x4x4_16b_bf16 v[44:47], v[6:7], v[136:137], v[44:47]
    v_mfma_f32_4x4x4_16b_bf16 v[60:63], v[6:7], v[138:139], v[60:63]
    s_and_b32 s54, s84, 12
    s_set_gpr_idx_on s54, gpr_idx(SRC2,DST)
    s_lshr_b32 s84, s84, 2
    s_waitcnt vmcnt(3)
    v_mfma_f32_4x4x4_16b_bf16 v[44:47], v[6:7], v[76:77], v[44:47]
    v_mfma_f32_4x4x4_16b_bf16 v[60:63], v[6:7], v[78:79], v[60:63]
    s_and_b32 s54, s84, 12
    s_set_gpr_idx_on s54, gpr_idx(SRC2,DST)
    s_lshr_b32 s84, s84, 2
    s_waitcnt vmcnt(2)
    v_mfma_f32_4x4x4_16b_bf16 v[44:47], v[6:7], v[80:81], v[44:47]
    v_mfma_f32_4x4x4_16b_bf16 v[60:63], v[6:7], v[82:83], v[60:63]
    s_and_b32 s54, s84, 12
    s_set_gpr_idx_on s54, gpr_idx(SRC2,DST)
    s_lshr_b32 s84, s84, 2
    s_waitcnt vmcnt(1)
    v_mfma_f32_4x4x4_16b_bf16 v[44:47], v[6:7], v[84:85], v[44:47]
    v_mfma_f32_4x4x4_16b_bf16 v[60:63], v[6:7], v[86:87], v[60:63]
    s_and_b32 s54, s84, 12
    s_set_gpr_idx_on s54, gpr_idx(SRC2,DST)
    s_cmp_eq_u32 s6, 7
    s_waitcnt vmcnt(0)
    v_mfma_f32_4x4x4_16b_bf16 v[44:47], v[6:7], v[88:89], v[44:47]
    v_mfma_f32_4x4x4_16b_bf16 v[60:63], v[6:7], v[90:91], v[60:63]
    s_set_gpr_idx_off
    s_branch K2_FIN2
HK_5:
    s_lshr_b32 s84, s84, 8
HT_5:
    s_and_b32 s54, s84, 12
    s_set_gpr_idx_on s54, gpr_idx(SRC2,DST)
    s_lshr_b32 s84, s84, 2
    s_waitcnt vmcnt(4)
    v_mfma_f32_4x4x4_16b_bf16 v[44:47], v[6:7], v[76:77], v[44:47]
    v_mfma_f32_4x4x4_16b_bf16 v[60:63], v[6:7], v[78:79], v[60:63]
    s_and_b32 s54, s84, 12
    s_set_gpr_idx_on s54, gpr_idx(SRC2,DST)
    s_lshr_b32 s84, s84, 2
    s_waitcnt vmcnt(3)
    v_mfma_f32_4x4x4_16b_bf16 v[44:47], v[6:7], v[80:81], v[44:47]
    v_mfma_f32_4x4x4_16b_bf16 v[60:63], v[6:7], v[82:83], v[60:63]
    s_and_b32 s54, s84, 12
    s_set_gpr_idx_on s54, gpr_idx(SRC2,DST)
    s_lshr_b32 s84, s84, 2
    s_waitcnt vmcnt(2)
    v_mfma_f32_4x4x4_16b_bf16 v[44:47], v[6:7], v[84:85], v[44:47]
    v_mfma_f32_4x4x4_16b_bf16 v[60:63], v[6:7], v[86:87], v[60:63]
    s_and_b32 s54, s84, 12
    s_set_gpr_idx_on s54, gpr_idx(SRC2,DST)
    s_lshr_b32 s84, s84, 2
    s_waitcnt vmcnt(1)
    v_mfma_f32_4x4x4_16b_bf16 v[44:47], v[6:7], v[88:89], v[44:47]
    v_mfma_f32_4x4x4_16b_bf16 v[60:63], v[6:7], v[90:91], v[60:63]
    s_and_b32 s54, s84, 12
    s_set_gpr_idx_on s54, gpr_idx(SRC2,DST)
    s_cmp_eq_u32 s6, 7
    s_waitcnt vmcnt(0)
    v_mfma_f32_4x4x4_16b_bf16 v[44:47], v[6:7], v[92:93], v[44:47]
    v_mfma_f32_4x4x4_16b_bf16 v[60:63], v[6:7], v[94:95], v[60:63]
    s_set_gpr_idx_off
    s_branch K2_FIN2
HK_6:
    s_lshr_b32 s84, s84, 10
HT_6:
    s_and_b32 s54, s84, 12
    s_set_gpr_idx_on s54, gpr_idx(SRC2,DST)
    s_lshr_b32 s84, s84, 2
    s_waitcnt vmcnt(4)
    v_mfma_f32_4x4x4_16b_bf16 v[44:47], v[6:7], v[80:81], v[44:47]
    v_mfma_f32_4x4x4_16b_bf16 v[60:63], v[6:7], v[82:83], v[60:63]
    s_and_b32 s54, s84, 12
    s_set_gpr_idx_on s54, gpr_idx(SRC2,DST)
    s_lshr_b32 s84, s84, 2
    s_waitcnt vmcnt(3)
    v_mfma_f32_4x4x4_16b_bf16 v[44:47], v[6:7], v[84:85], v[44:47]
    v_mfma_f32_4x4x4_16b_bf16 v[60:63], v[6:7], v[86:87], v[60:63]
    s_and_b32 s54, s84, 12
    s_set_gpr_idx_on s54, gpr_idx(SRC2,DST)
    s_lshr_b32 s84, s84, 2
    s_waitcnt vmcnt(2)
    v_mfma_f32_4x4x4_16b_bf16 v[44:47], v[6:7], v[88:89], v[44:47]
    v_mfma_f32_4x4x4_16b_bf16 v[60:63], v[6:7], v[90:91], v[60:63]
    s_and_b32 s54, s84, 12
    s_set_gpr_idx_on s54, gpr_idx(SRC2,DST)
    s_lshr_b32 s84, s84, 2
    s_waitcnt vmcnt(1)
    v_mfma_f32_4x4x4_16b_bf16 v[44:47], v[6:7], v[92:93], v[44:47]
    v_mfma_f32_4x4x4_16b_bf16 v[60:63], v[6:7], v[94:95], v[60:63]
    s_and_b32 s54, s84, 12
    s_set_gpr_idx_on s54, gpr_idx(SRC2,DST)
    s_cmp_eq_u32 s6, 7
    s_waitcnt vmcnt(0)
    v_mfma_f32_4x4x4_16b_bf16 v[44:47], v[6:7], v[96:97], v[44:47]
    v_mfma_f32_4x4x4_16b_bf16 v[60:63], v[6:7], v[98:99], v[60:63]
    s_set_gpr_idx_off
    s_branch K2_FIN2
HK_7:
    s_lshr_b32 s84, s84, 12
HT_7:
    s_and_b32 s54, s84, 12
    s_set_gpr_idx_on s54, gpr_idx(SRC2,DST)
    s_lshr_b32 s84, s84, 2
    s_waitcnt vmcnt(4)
    v_mfma_f32_4x4x4_16b_bf16 v[44:47], v[6:7], v[84:85], v[44:47]
    v_mfma_f32_4x4x4_16b_bf16 v[60:63], v[6:7], v[86:87], v[60:63]
    s_and_b32 s54, s84, 12
    s_set_gpr_idx_on s54, gpr_idx(SRC2,DST)
    s_lshr_b32 s84, s84, 2
    s_waitcnt vmcnt(3)
    v_mfma_f32_4x4x4_16b_bf16 v[44:47], v[6:7], v[88:89], v[44:47]
    v_mfma_f32_4x4x4_16b_bf16 v[60:63], v[6:7], v[90:91], v[60:63]
    s_and_b32 s54, s84, 12
    s_set_gpr_idx_on s54, gpr_idx(SRC2,DST)
    s_lshr_b32 s84, s84, 2
    s_waitcnt vmcnt(2)
    v_mfma_f32_4x4x4_16b_bf16 v[44:47], v[6:7], v[92:93], v[44:47]
    v_mfma_f32_4x4x4_16b_bf16 v[60:63], v[6:7], v[94:95], v[60:63]
    s_and_b32 s54, s84, 12
    s_set_gpr_idx_on s54, gpr_idx(SRC2,DST)
    s_lshr_b32 s84, s84, 2
    s_waitcnt vmcnt(1)
    v_mfma_f32_4x4x4_16b_bf16 v[44:47], v[6:7], v[96:97], v[44:47]
    v_mfma_f32_4x4x4_16b_bf16 v[60:63], v[6:7], v[98:99], v[60:63]
    s_and_b32 s54, s84, 12
    s_set_gpr_idx_on s54, gpr_idx(SRC2,DST)
    s_cmp_eq_u32 s6, 7
    s_waitcnt vmcnt(0)
    v_mfma_f32_4x4x4_16b_bf16 v[44:47], v[6:7], v[132:133], v[44:47]
    v_mfma_f32_4x4x4_16b_bf16 v[60:63], v[6:7], v[134:135], v[60:63]
    s_set_gpr_idx_off
    s_branch K2_FIN2
K2_FIN:
    s_cmp_eq_u32 s6, 7
K2_FIN2:
    s_cbranch_scc1 K2_LAST
    s_nop 1
    v_pk_mul_f32 v[76:77], v[44:45], v[16:17] op_sel_hi:[1,0]
    v_pk_mul_f32 v[78:79], v[46:47], v[16:17] op_sel_hi:[1,0]
    v_pk_mul_f32 v[80:81], v[60:61], v[16:17] op_sel_hi:[1,0]
    v_pk_mul_f32 v[82:83], v[62:63], v[16:17] op_sel_hi:[1,0]
    v_cvt_pk_bf16_f32 v76, v76, v77
    v_cvt_pk_bf16_f32 v77, v78, v79
    v_cvt_pk_bf16_f32 v78, v80, v81
    v_cvt_pk_bf16_f32 v79, v82, v83
    s_or_b64 exec, s[42:43], 1
    buffer_store_dwordx4 v[76:79], v152, s[20:23], 0 offen sc1
    s_mov_b64 exec, -1
    v_pk_mul_f32 v[84:85], v[48:49], v[18:19] op_sel_hi:[1,0]
    v_pk_mul_f32 v[86:87], v[50:51], v[18:19] op_sel_hi:[1,0]
    v_pk_mul_f32 v[88:89], v[64:65], v[18:19] op_sel_hi:[1,0]
    v_pk_mul_f32 v[90:91], v[66:67], v[18:19] op_sel_hi:[1,0]
    v_cvt_pk_bf16_f32 v84, v84, v85
    v_cvt_pk_bf16_f32 v85, v86, v87
    v_cvt_pk_bf16_f32 v86, v88, v89
    v_cvt_pk_bf16_f32 v87, v90, v91
    s_or_b64 exec, s[44:45], 1
    buffer_store_dwordx4 v[84:87], v153, s[20:23], 0 offen sc1
    s_mov_b64 exec, -1
    v_pk_mul_f32 v[132:133], v[52:53], v[20:21] op_sel_hi:[1,0]
    v_pk_mul_f32 v[134:135], v[54:55], v[20:21] op_sel_hi:[1,0]
    v_pk_mul_f32 v[136:137], v[68:69], v[20:21] op_sel_hi:[1,0]
    v_pk_mul_f32 v[138:139], v[70:71], v[20:21] op_sel_hi:[1,0]
    v_cvt_pk_bf16_f32 v132, v132, v133
    v_cvt_pk_bf16_f32 v133, v134, v135
    v_cvt_pk_bf16_f32 v134, v136, v137
    v_cvt_pk_bf16_f32 v135, v138, v139
    s_or_b64 exec, s[46:47], 1
    buffer_store_dwordx4 v[132:135], v154, s[20:23], 0 offen sc1
    s_mov_b64 exec, -1
    s_cmp_lg_u32 s3, 7
    s_cbranch_scc1 K2_PUB3
    v_pk_mul_f32 v[92:93], v[56:57], v[22:23] op_sel_hi:[1,0]
    v_pk_mul_f32 v[94:95], v[58:59], v[22:23] op_sel_hi:[1,0]
    v_pk_mul_f32 v[96:97], v[72:73], v[22:23] op_sel_hi:[1,0]
    v_pk_mul_f32 v[98:99], v[74:75], v[22:23] op_sel_hi:[1,0]
    v_cvt_pk_bf16_f32 v92, v92, v93
    v_cvt_pk_bf16_f32 v93, v94, v95
    v_cvt_pk_bf16_f32 v94, v96, v97
    v_cvt_pk_bf16_f32 v95, v98, v99
    s_or_b64 exec, s[48:49], 1
    buffer_store_dwordx4 v[92:95], v155, s[20:23], 0 offen sc1
    s_mov_b64 exec, -1
    buffer_store_dwordx4 v[92:95], v11, s[20:23], 0 offen sc1
K2_PUB3:
    buffer_store_dwordx4 v[76:79], v8, s[20:23], 0 offen sc1
    buffer_store_dwordx4 v[84:87], v9, s[20:23], 0 offen sc1
    buffer_store_dwordx4 v[132:135], v10, s[20:23], 0 offen sc1
K2_PUB_DONE:
    s_cmp_lg_u32 s2, 255
    s_cbranch_scc1 K2_WDONE
    s_cmp_le_u32 s6, 2
    s_cbranch_scc1 S_WEIGHTS
K2_WDONE:
    s_setprio 0
    s_bitcmp0_b32 15, s3
    s_cbranch_scc1 K2_ARRIVE
K2_LAST:
    s_mul_i32 s60, s6, 0x90
    s_bitcmp1_b32 s60, 4
    s_cselect_b32 s61, 0xffff0000, s63
    s_bitcmp1_b32 s60, 5
    s_cselect_b32 s57, s61, 0
    s_cselect_b32 s61, 0, s61
    s_lshl_b32 s62, s6, 3
    v_pk_add_f32 v[148:149], v[44:45], v[46:47]
    v_pk_add_f32 v[152:153], v[48:49], v[50:51]
    v_pk_add_f32 v[156:157], v[52:53], v[54:55]
    v_pk_mul_f32 v[150:151], v[44:45], v[44:45]
    v_pk_mul_f32 v[154:155], v[48:49], v[48:49]
    v_pk_mul_f32 v[158:159], v[52:53], v[52:53]
    v_pk_fma_f32 v[150:151], v[46:47], v[46:47], v[150:151]
    v_pk_fma_f32 v[154:155], v[50:51], v[50:51], v[154:155]
    v_pk_fma_f32 v[158:159], v[54:55], v[54:55], v[158:159]
    v_pk_add_f32 v[148:149], v[148:149], v[60:61]
    v_pk_add_f32 v[152:153], v[152:153], v[64:65]
    v_pk_add_f32 v[156:157], v[156:157], v[68:69]
    v_pk_fma_f32 v[150:151], v[60:61], v[60:61], v[150:151]
    v_pk_fma_f32 v[154:155], v[64:65], v[64:65], v[154:155]
    v_pk_fma_f32 v[158:159], v[68:69], v[68:69], v[158:159]
    v_pk_add_f32 v[148:149], v[148:149], v[62:63]
    v_pk_add_f32 v[152:153], v[152:153], v[66:67]
    v_pk_add_f32 v[156:157], v[156:157], v[70:71]
    v_pk_fma_f32 v[150:151], v[62:63], v[62:63], v[150:151]
    v_pk_fma_f32 v[154:155], v[66:67], v[66:67], v[154:155]
    v_pk_fma_f32 v[158:159], v[70:71], v[70:71], v[158:159]
    v_add_f32 v148, v148, v149
    v_add_f32 v152, v152, v153
    v_add_f32 v156, v156, v157
    v_add_f32 v149, v150, v151
    v_add_f32 v153, v154, v155
    v_add_f32 v157, v158, v159
    v_add_f32_dpp v148, v148, v148 quad_perm:[1,0,3,2] row_mask:0xf bank_mask:0xf
    v_add_f32_dpp v152, v152, v152 quad_perm:[1,0,3,2] row_mask:0xf bank_mask:0xf
    v_add_f32_dpp v156, v156, v156 quad_perm:[1,0,3,2] row_mask:0xf bank_mask:0xf
    v_add_f32_dpp v149, v149, v149 quad_perm:[1,0,3,2] row_mask:0xf bank_mask:0xf
    v_add_f32_dpp v153, v153, v153 quad_perm:[1,0,3,2] row_mask:0xf bank_mask:0xf
    v_add_f32_dpp v157, v157, v157 quad_perm:[1,0,3,2] row_mask:0xf bank_mask:0xf
    v_add_f32_dpp v148, v148, v148 quad_perm:[2,3,0,1] row_mask:0xf bank_mask:0xf
    v_add_f32_dpp v152, v152, v152 quad_perm:[2,3,0,1] row_mask:0xf bank_mask:0xf
    v_add_f32_dpp v156, v156, v156 quad_perm:[2,3,0,1] row_mask:0xf bank_mask:0xf
    v_add_f32_dpp v149, v149, v149 quad_perm:[2,3,0,1] row_mask:0xf bank_mask:0xf
    v_add_f32_dpp v153, v153, v153 quad_perm:[2,3,0,1] row_mask:0xf bank_mask:0xf
    v_add_f32_dpp v157, v157, v157 quad_perm:[2,3,0,1] row_mask:0xf bank_mask:0xf
    v_add_f32_dpp v148, v148, v148 row_half_mirror row_mask:0xf bank_mask:0xf
    v_add_f32_dpp v152, v152, v152 row_half_mirror row_mask:0xf bank_mask:0xf
    v_add_f32_dpp v156, v156, v156 row_half_mirror row_mask:0xf bank_mask:0xf
    v_add_f32_dpp v149, v149, v149 row_half_mirror row_mask:0xf bank_mask:0xf
    v_add_f32_dpp v153, v153, v153 row_half_mirror row_mask:0xf bank_mask:0xf
    v_add_f32_dpp v157, v157, v157 row_half_mirror row_mask:0xf bank_mask:0xf
    v_mul_f32 v151, 0xbc800000, v148
    v_mul_f32 v155, 0xbc800000, v152
    v_mul_f32 v159, 0xbc800000, v156
    v_mov_b32 v150, 0x3727c5ac
    v_mov_b32 v154, 0x3727c5ac
    v_mov_b32 v158, 0x3727c5ac
    v_fmac_f32 v149, v151, v148
    v_fmac_f32 v153, v155, v152
    v_fmac_f32 v157, v159, v156
    v_max_f32 v149, 0, v149
    v_max_f32 v153, 0, v153
    v_max_f32 v157, 0, v157
    v_mul_f32 v149, v149, v16
    v_mul_f32 v153, v153, v18
    v_mul_f32 v157, v157, v20
    v_fmac_f32 v150, 0x3c800000, v149
    v_fmac_f32 v154, 0x3c800000, v153
    v_fmac_f32 v158, 0x3c800000, v157
    v_sqrt_f32 v149, v150
    v_sqrt_f32 v153, v154
    v_sqrt_f32 v157, v158
    v_cvt_pk_bf16_f32 v149, v149, v149
    v_cvt_pk_bf16_f32 v153, v153, v153
    v_cvt_pk_bf16_f32 v157, v157, v157
    v_and_b32 v150, 0xffff0000, v149
    v_and_b32 v154, 0xffff0000, v153
    v_and_b32 v158, 0xffff0000, v157
    v_rcp_f32 v150, v150
    v_rcp_f32 v154, v154
    v_rcp_f32 v158, v158
    v_mul_f32 v144, -v151, v17
    v_mul_f32 v145, -v155, v19
    v_mul_f32 v146, -v159, v21
    v_mul_f32 v150, v150, v17
    v_mul_f32 v154, v154, v19
    v_mul_f32 v158, v158, v21
    v_mul_f32 v148, v151, v150
    v_mul_f32 v152, v155, v154
    v_mul_f32 v156, v159, v158
    v_pk_fma_f32 v[44:45], v[44:45], v[150:151], v[148:149] op_sel_hi:[1,0,0]
    v_pk_fma_f32 v[48:49], v[48:49], v[154:155], v[152:153] op_sel_hi:[1,0,0]
    v_pk_fma_f32 v[52:53], v[52:53], v[158:159], v[156:157] op_sel_hi:[1,0,0]
    v_pk_fma_f32 v[46:47], v[46:47], v[150:151], v[148:149] op_sel_hi:[1,0,0]
    v_pk_fma_f32 v[50:51], v[50:51], v[154:155], v[152:153] op_sel_hi:[1,0,0]
    v_pk_fma_f32 v[54:55], v[54:55], v[158:159], v[156:157] op_sel_hi:[1,0,0]
    v_pk_fma_f32 v[60:61], v[60:61], v[150:151], v[148:149] op_sel_hi:[1,0,0]
    v_pk_fma_f32 v[64:65], v[64:65], v[154:155], v[152:153] op_sel_hi:[1,0,0]
    v_pk_fma_f32 v[68:69], v[68:69], v[158:159], v[156:157] op_sel_hi:[1,0,0]
    v_pk_fma_f32 v[62:63], v[62:63], v[150:151], v[148:149] op_sel_hi:[1,0,0]
    v_pk_fma_f32 v[66:67], v[66:67], v[154:155], v[152:153] op_sel_hi:[1,0,0]
    v_pk_fma_f32 v[70:71], v[70:71], v[158:159], v[156:157] op_sel_hi:[1,0,0]
    v_and_b32 v148, s61, v149
    v_and_b32 v152, s61, v153
    v_and_b32 v156, s61, v157
    v_and_b32 v149, s57, v149
    v_and_b32 v153, s57, v153
    v_and_b32 v157, s57, v157
    v_cvt_pk_bf16_f32 v132, v44, v45
    v_cvt_pk_bf16_f32 v136, v48, v49
    v_cvt_pk_bf16_f32 v133, v46, v47
    v_cvt_pk_bf16_f32 v137, v50, v51
    v_cvt_pk_bf16_f32 v134, v60, v61
    v_cvt_pk_bf16_f32 v138, v64, v65
    v_cvt_pk_bf16_f32 v135, v62, v63
    v_cvt_pk_bf16_f32 v139, v66, v67
    s_lshr_b32 s54, s62, 1
    s_set_gpr_idx_on s54, gpr_idx(DST)
    v_cvt_pk_bf16_f32 v100, v52, v53
    v_cvt_pk_bf16_f32 v101, v54, v55
    v_cvt_pk_bf16_f32 v102, v68, v69
    v_cvt_pk_bf16_f32 v103, v70, v71
    s_set_gpr_idx_off
    v_xor_b32 v3, s60, v4
    v_add_u32 v151, s62, v5
    ds_write_b128 v3, v[132:135]
    v_lshrrev_b32 v150, 1, v151
    v_add_u32 v150, 82432, v150
    ds_write_b128 v3, v[136:139] offset:8192
    s_mov_b64 exec, s[58:59]
    ds_write_b64 v151, v[148:149] offset:0
    ds_write_b32 v150, v144 offset:0
    ds_write_b64 v151, v[152:153] offset:512
    ds_write_b32 v150, v145 offset:256
    ds_write_b64 v151, v[156:157] offset:1024
    ds_write_b32 v150, v146 offset:512
    s_mov_b64 exec, -1
    s_cmp_lg_u32 s3, 7
    s_cbranch_scc1 TOK_DONE_H
    v_pk_add_f32 v[152:153], v[56:57], v[58:59]
    v_pk_mul_f32 v[154:155], v[56:57], v[56:57]
    v_pk_fma_f32 v[154:155], v[58:59], v[58:59], v[154:155]
    v_pk_add_f32 v[152:153], v[152:153], v[72:73]
    v_pk_fma_f32 v[154:155], v[72:73], v[72:73], v[154:155]
    v_pk_add_f32 v[152:153], v[152:153], v[74:75]
    v_pk_fma_f32 v[154:155], v[74:75], v[74:75], v[154:155]
    v_add_f32 v152, v152, v153
    v_add_f32 v153, v154, v155
    s_nop 0
    v_add_f32_dpp v152, v152, v152 quad_perm:[1,0,3,2] row_mask:0xf bank_mask:0xf
    v_add_f32_dpp v153, v153, v153 quad_perm:[1,0,3,2] row_mask:0xf bank_mask:0xf
    s_nop 0
    v_add_f32_dpp v152, v152, v152 quad_perm:[2,3,0,1] row_mask:0xf bank_mask:0xf
    v_add_f32_dpp v153, v153, v153 quad_perm:[2,3,0,1] row_mask:0xf bank_mask:0xf
    s_nop 0
    v_add_f32_dpp v152, v152, v152 row_half_mirror row_mask:0xf bank_mask:0xf
    v_add_f32_dpp v153, v153, v153 row_half_mirror row_mask:0xf bank_mask:0xf
    v_mul_f32 v155, 0xbc800000, v152
    v_mov_b32 v154, 0x3727c5ac
    v_fmac_f32 v153, v155, v152
    v_max_f32 v153, 0, v153
    v_mul_f32 v153, v153, v22
    v_fmac_f32 v154, 0x3c800000, v153
    v_sqrt_f32 v153, v154
    s_nop 0
    v_cvt_pk_bf16_f32 v153, v153, v153
    v_and_b32 v154, 0xffff0000, v153
    v_rcp_f32 v154, v154
    v_mul_f32 v144, -v155, v23
    v_mul_f32 v154, v154, v23
    v_mul_f32 v152, v155, v154
    v_pk_fma_f32 v[56:57], v[56:57], v[154:155], v[152:153] op_sel_hi:[1,0,0]
    v_pk_fma_f32 v[58:59], v[58:59], v[154:155], v[152:153] op_sel_hi:[1,0,0]
    v_pk_fma_f32 v[72:73], v[72:73], v[154:155], v[152:153] op_sel_hi:[1,0,0]
    v_pk_fma_f32 v[74:75], v[74:75], v[154:155], v[152:153] op_sel_hi:[1,0,0]
    v_and_b32 v152, s61, v153
    v_and_b32 v153, s57, v153
    v_cvt_pk_bf16_f32 v140, v56, v57
    v_cvt_pk_bf16_f32 v141, v58, v59
    v_cvt_pk_bf16_f32 v142, v72, v73
    v_cvt_pk_bf16_f32 v143, v74, v75
    ds_write_b128 v3, v[140:143] offset:16384
    s_mov_b64 exec, s[58:59]
    ds_write_b64 v151, v[152:153] offset:1536
    ds_write_b32 v150, v144 offset:768
    s_mov_b64 exec, -1
TOK_DONE_H:
    s_cmp_eq_u32 s6, 7
    s_cbranch_scc1 K2_FINAL
    s_bitcmp0_b32 15, s3
    s_cbranch_scc1 K2_EXTRA
    s_cmp_lg_u32 s3, 0
    s_cbranch_scc1 K2_ARRIVE
    s_setprio 3
    s_add_u32 s36, s36, 32768
    s_addc_u32 s37, s37, 0
    s_mov_b64 exec, 0xffff
    s_waitcnt vmcnt(0)
    s_barrier
    global_atomic_add v172, v174, s[36:37]
    s_mov_b64 exec, -1
    s_branch K2_EXTRA
K2_ARRIVE:
    s_waitcnt vmcnt(0)
    s_barrier
    s_bitcmp0_b32 15, s3
    s_cbranch_scc1 K2_LAST
K2_EXTRA:
    s_cmp_lg_u32 s6, 3
    s_cbranch_scc1 K2_NOE3
    s_add_u32 s54, s14, 104136704
    s_addc_u32 s55, s15, 0
    s_lshl_b32 s56, s3, 11
    v_lshl_add_u32 v132, v1, 4, s56
    s_and_b32 s56, s3, 1
    s_lshl_b32 s56, s56, 10
    s_add_u32 s56, s56, 16384
    v_lshl_add_u32 v133, v1, 4, s56
    v_mov_b32 v134, 20732
    global_load_dwordx4 v[192:195], v132, s[54:55] sc1
    global_load_dwordx4 v[196:199], v132, s[54:55] offset:1024 sc1
    global_load_dwordx4 v[200:203], v133, s[54:55] sc1
    global_load_dword v204, v134, s[54:55] sc1
K2_NOE3:
    s_cmp_lg_u32 s6, 4
    s_cbranch_scc1 K2_NOE4
    v_lshrrev_b32 v144, 3, v1
    v_lshl_add_u32 v144, v144, 10, v2
    v_lshlrev_b32 v145, 4, v1
    v_add_u32 v145, 158976, v145
    s_lshl_b32 s56, s3, 14
    v_add_u32 v144, s56, v144
    s_and_b32 s56, s3, 1
    s_lshl_b32 s56, s56, 10
    v_add_u32 v145, s56, v145
    v_readfirstlane_b32 s53, v204
    ds_write_b128 v144, v[192:195] offset:896
    ds_write_b128 v144, v[196:199] offset:9088
    ds_write_b128 v145, v[200:203]
K2_NOE4:
    s_mov_b32 s16, s20
    s_mov_b32 s17, s21
    s_add_u32 s20, s20, 12582912
    s_addc_u32 s21, s21, 0
    s_add_u32 s6, s6, 1
    s_setprio 3
    s_branch K2_WAIT
K2_DEEP:
    v_xor_b32_dpp v3, v29, v0 quad_perm:[1,1,1,1] row_mask:0xf bank_mask:0xf
    buffer_load_dwordx4 v[96:99], v3, s[16:19], 0 offen sc1
    s_lshl_b64 s[84:85], s[38:39], 12
    s_lshl_b64 s[86:87], s[40:41], 12
    s_lshr_b32 s54, s39, 20
    s_lshr_b32 s88, s41, 20
    s_or_b32 s86, s86, s54
    s_mov_b32 s89, s7
    s_mov_b32 s91, 0
    v_mov_b32 v140, v28
    v_mov_b32 v141, v29
    v_mov_b32 v142, v30
    v_mov_b32 v143, v31
    s_branch HNL_5
    .p2align 6
HLL:
    s_add_u32 s91, s91, 4
    s_set_gpr_idx_on s91, gpr_idx(SRC0)
    v_mov_b32 v140, v28
    v_mov_b32 v141, v29
    v_mov_b32 v142, v30
    v_mov_b32 v143, v31
    s_set_gpr_idx_off
    s_mov_b32 s84, s85
    s_mov_b32 s85, s86
    s_mov_b32 s86, s87
    s_mov_b32 s87, s88
    s_sub_i32 s89, s89, 16
    s_cmp_gt_i32 s89, 0
    s_cbranch_scc0 HKL_0
    v_xor_b32_dpp v3, v140, v0 quad_perm:[0,0,0,0] row_mask:0xf bank_mask:0xf
    s_bfe_u32 s54, s84, 0x20000
    s_lshl_b32 s54, s54, 2
    s_set_gpr_idx_on s54, gpr_idx(SRC2,DST)
    s_waitcnt vmcnt(5)
    buffer_load_dwordx4 v[76:79], v3, s[16:19], 0 offen sc1
    v_mfma_f32_4x4x4_16b_bf16 v[44:47], v[6:7], v[84:85], v[44:47]
    v_mfma_f32_4x4x4_16b_bf16 v[60:63], v[6:7], v[86:87], v[60:63]
    s_set_gpr_idx_off
HNL_0:
    s_cmp_gt_i32 s89, 1
    s_cbranch_scc0 HKL_1
    v_xor_b32_dpp v3, v141, v0 quad_perm:[0,0,0,0] row_mask:0xf bank_mask:0xf
    s_bfe_u32 s54, s84, 0x20002
    s_lshl_b32 s54, s54, 2
    s_set_gpr_idx_on s54, gpr_idx(SRC2,DST)
    s_waitcnt vmcnt(5)
    buffer_load_dwordx4 v[80:83], v3, s[16:19], 0 offen sc1
    v_mfma_f32_4x4x4_16b_bf16 v[44:47], v[6:7], v[88:89], v[44:47]
    v_mfma_f32_4x4x4_16b_bf16 v[60:63], v[6:7], v[90:91], v[60:63]
    s_set_gpr_idx_off
HNL_1:
    s_cmp_gt_i32 s89, 2
    s_cbranch_scc0 HKL_2
    v_xor_b32_dpp v3, v142, v0 quad_perm:[0,0,0,0] row_mask:0xf bank_mask:0xf
    s_bfe_u32 s54, s84, 0x20004
    s_lshl_b32 s54, s54, 2
    s_set_gpr_idx_on s54, gpr_idx(SRC2,DST)
    s_waitcnt vmcnt(5)
    buffer_load_dwordx4 v[84:87], v3, s[16:19], 0 offen sc1
    v_mfma_f32_4x4x4_16b_bf16 v[44:47], v[6:7], v[92:93], v[44:47]
    v_mfma_f32_4x4x4_16b_bf16 v[60:63], v[6:7], v[94:95], v[60:63]
    s_set_gpr_idx_off
HNL_2:
    s_cmp_gt_i32 s89, 3
    s_cbranch_scc0 HKL_3
    v_xor_b32_dpp v3, v143, v0 quad_perm:[0,0,0,0] row_mask:0xf bank_mask:0xf
    s_bfe_u32 s54, s84, 0x20006
    s_lshl_b32 s54, s54, 2
    s_set_gpr_idx_on s54, gpr_idx(SRC2,DST)
    s_waitcnt vmcnt(5)
    buffer_load_dwordx4 v[88:91], v3, s[16:19], 0 offen sc1
    v_mfma_f32_4x4x4_16b_bf16 v[44:47], v[6:7], v[96:97], v[44:47]
    v_mfma_f32_4x4x4_16b_bf16 v[60:63], v[6:7], v[98:99], v[60:63]
    s_set_gpr_idx_off
HNL_3:
    s_cmp_gt_i32 s89, 4
    s_cbranch_scc0 HKL_4
    v_xor_b32_dpp v3, v140, v0 quad_perm:[1,1,1,1] row_mask:0xf bank_mask:0xf
    s_bfe_u32 s54, s84, 0x20008
    s_lshl_b32 s54, s54, 2
    s_set_gpr_idx_on s54, gpr_idx(SRC2,DST)
    s_waitcnt vmcnt(5)
    buffer_load_dwordx4 v[92:95], v3, s[16:19], 0 offen sc1
    v_mfma_f32_4x4x4_16b_bf16 v[44:47], v[6:7], v[132:133], v[44:47]
    v_mfma_f32_4x4x4_16b_bf16 v[60:63], v[6:7], v[134:135], v[60:63]
    s_set_gpr_idx_off
HNL_4:
    s_cmp_gt_i32 s89, 5
    s_cbranch_scc0 HKL_5
    v_xor_b32_dpp v3, v141, v0 quad_perm:[1,1,1,1] row_mask:0xf bank_mask:0xf
    s_bfe_u32 s54, s84, 0x2000a
    s_lshl_b32 s54, s54, 2
    s_set_gpr_idx_on s54, gpr_idx(SRC2,DST)
    s_waitcnt vmcnt(5)
    buffer_load_dwordx4 v[96:99], v3, s[16:19], 0 offen sc1
    v_mfma_f32_4x4x4_16b_bf16 v[44:47], v[6:7], v[136:137], v[44:47]
    v_mfma_f32_4x4x4_16b_bf16 v[60:63], v[6:7], v[138:139], v[60:63]
    s_set_gpr_idx_off
HNL_5:
    s_cmp_gt_i32 s89, 6
    s_cbranch_scc0 HKL_6
    v_xor_b32_dpp v3, v142, v0 quad_perm:[1,1,1,1] row_mask:0xf bank_mask:0xf
    s_bfe_u32 s54, s84, 0x2000c
    s_lshl_b32 s54, s54, 2
    s_set_gpr_idx_on s54, gpr_idx(SRC2,DST)
    s_waitcnt vmcnt(5)
    buffer_load_dwordx4 v[132:135], v3, s[16:19], 0 offen sc1
    v_mfma_f32_4x4x4_16b_bf16 v[44:47], v[6:7], v[76:77], v[44:47]
    v_mfma_f32_4x4x4_16b_bf16 v[60:63], v[6:7], v[78:79], v[60:63]
    s_set_gpr_idx_off
HNL_6:
    s_cmp_gt_i32 s89, 7
    s_cbranch_scc0 HKL_7
    v_xor_b32_dpp v3, v143, v0 quad_perm:[1,1,1,1] row_mask:0xf bank_mask:0xf
    s_bfe_u32 s54, s84, 0x2000e
    s_lshl_b32 s54, s54, 2
    s_set_gpr_idx_on s54, gpr_idx(SRC2,DST)
    s_waitcnt vmcnt(5)
    buffer_load_dwordx4 v[136:139], v3, s[16:19], 0 offen sc1
    v_mfma_f32_4x4x4_16b_bf16 v[44:47], v[6:7], v[80:81], v[44:47]
    v_mfma_f32_4x4x4_16b_bf16 v[60:63], v[6:7], v[82:83], v[60:63]
    s_set_gpr_idx_off
HNL_7:
    s_cmp_gt_i32 s89, 8
    s_cbranch_scc0 HKL_8
    v_xor_b32_dpp v3, v140, v0 quad_perm:[2,2,2,2] row_mask:0xf bank_mask:0xf
    s_bfe_u32 s54, s84, 0x20010
    s_lshl_b32 s54, s54, 2
    s_set_gpr_idx_on s54, gpr_idx(SRC2,DST)
    s_waitcnt vmcnt(5)
    buffer_load_dwordx4 v[76:79], v3, s[16:19], 0 offen sc1
    v_mfma_f32_4x4x4_16b_bf16 v[44:47], v[6:7], v[84:85], v[44:47]
    v_mfma_f32_4x4x4_16b_bf16 v[60:63], v[6:7], v[86:87], v[60:63]
    s_set_gpr_idx_off
HNL_8:
    s_cmp_gt_i32 s89, 9
    s_cbranch_scc0 HKL_9
    v_xor_b32_dpp v3, v141, v0 quad_perm:[2,2,2,2] row_mask:0xf bank_mask:0xf
    s_bfe_u32 s54, s84, 0x20012
    s_lshl_b32 s54, s54, 2
    s_set_gpr_idx_on s54, gpr_idx(SRC2,DST)
    s_waitcnt vmcnt(5)
    buffer_load_dwordx4 v[80:83], v3, s[16:19], 0 offen sc1
    v_mfma_f32_4x4x4_16b_bf16 v[44:47], v[6:7], v[88:89], v[44:47]
    v_mfma_f32_4x4x4_16b_bf16 v[60:63], v[6:7], v[90:91], v[60:63]
    s_set_gpr_idx_off
HNL_9:
    s_cmp_gt_i32 s89, 10
    s_cbranch_scc0 HKL_10
    v_xor_b32_dpp v3, v142, v0 quad_perm:[2,2,2,2] row_mask:0xf bank_mask:0xf
    s_bfe_u32 s54, s84, 0x20014
    s_lshl_b32 s54, s54, 2
    s_set_gpr_idx_on s54, gpr_idx(SRC2,DST)
    s_waitcnt vmcnt(5)
    buffer_load_dwordx4 v[84:87], v3, s[16:19], 0 offen sc1
    v_mfma_f32_4x4x4_16b_bf16 v[44:47], v[6:7], v[92:93], v[44:47]
    v_mfma_f32_4x4x4_16b_bf16 v[60:63], v[6:7], v[94:95], v[60:63]
    s_set_gpr_idx_off
HNL_10:
    s_cmp_gt_i32 s89, 11
    s_cbranch_scc0 HKL_11
    v_xor_b32_dpp v3, v143, v0 quad_perm:[2,2,2,2] row_mask:0xf bank_mask:0xf
    s_bfe_u32 s54, s84, 0x20016
    s_lshl_b32 s54, s54, 2
    s_set_gpr_idx_on s54, gpr_idx(SRC2,DST)
    s_waitcnt vmcnt(5)
    buffer_load_dwordx4 v[88:91], v3, s[16:19], 0 offen sc1
    v_mfma_f32_4x4x4_16b_bf16 v[44:47], v[6:7], v[96:97], v[44:47]
    v_mfma_f32_4x4x4_16b_bf16 v[60:63], v[6:7], v[98:99], v[60:63]
    s_set_gpr_idx_off
HNL_11:
    s_cmp_gt_i32 s89, 12
    s_cbranch_scc0 HKL_12
    v_xor_b32_dpp v3, v140, v0 quad_perm:[3,3,3,3] row_mask:0xf bank_mask:0xf
    s_bfe_u32 s54, s84, 0x20018
    s_lshl_b32 s54, s54, 2
    s_set_gpr_idx_on s54, gpr_idx(SRC2,DST)
    s_waitcnt vmcnt(5)
    buffer_load_dwordx4 v[92:95], v3, s[16:19], 0 offen sc1
    v_mfma_f32_4x4x4_16b_bf16 v[44:47], v[6:7], v[132:133], v[44:47]
    v_mfma_f32_4x4x4_16b_bf16 v[60:63], v[6:7], v[134:135], v[60:63]
    s_set_gpr_idx_off
HNL_12:
    s_cmp_gt_i32 s89, 13
    s_cbranch_scc0 HKL_13
    v_xor_b32_dpp v3, v141, v0 quad_perm:[3,3,3,3] row_mask:0xf bank_mask:0xf
    s_bfe_u32 s54, s84, 0x2001a
    s_lshl_b32 s54, s54, 2
    s_set_gpr_idx_on s54, gpr_idx(SRC2,DST)
    s_waitcnt vmcnt(5)
    buffer_load_dwordx4 v[96:99], v3, s[16:19], 0 offen sc1
    v_mfma_f32_4x4x4_16b_bf16 v[44:47], v[6:7], v[136:137], v[44:47]
    v_mfma_f32_4x4x4_16b_bf16 v[60:63], v[6:7], v[138:139], v[60:63]
    s_set_gpr_idx_off
HNL_13:
    s_cmp_gt_i32 s89, 14
    s_cbranch_scc0 HKL_14
    v_xor_b32_dpp v3, v142, v0 quad_perm:[3,3,3,3] row_mask:0xf bank_mask:0xf
    s_bfe_u32 s54, s84, 0x2001c
    s_lshl_b32 s54, s54, 2
    s_set_gpr_idx_on s54, gpr_idx(SRC2,DST)
    s_waitcnt vmcnt(5)
    buffer_load_dwordx4 v[132:135], v3, s[16:19], 0 offen sc1
    v_mfma_f32_4x4x4_16b_bf16 v[44:47], v[6:7], v[76:77], v[44:47]
    v_mfma_f32_4x4x4_16b_bf16 v[60:63], v[6:7], v[78:79], v[60:63]
    s_set_gpr_idx_off
HNL_14:
    s_cmp_gt_i32 s89, 15
    s_cbranch_scc0 HKL_15
    v_xor_b32_dpp v3, v143, v0 quad_perm:[3,3,3,3] row_mask:0xf bank_mask:0xf
    s_bfe_u32 s54, s84, 0x2001e
    s_lshl_b32 s54, s54, 2
    s_set_gpr_idx_on s54, gpr_idx(SRC2,DST)
    s_waitcnt vmcnt(5)
    buffer_load_dwordx4 v[136:139], v3, s[16:19], 0 offen sc1
    v_mfma_f32_4x4x4_16b_bf16 v[44:47], v[6:7], v[80:81], v[44:47]
    v_mfma_f32_4x4x4_16b_bf16 v[60:63], v[6:7], v[82:83], v[60:63]
    s_set_gpr_idx_off
HNL_15:
    s_branch HLL
HKL_8:
    s_lshr_b64 s[84:85], s[84:85], 14
    s_branch HTL_0
HKL_9:
    s_lshr_b64 s[84:85], s[84:85], 16
    s_branch HTL_1
HKL_10:
    s_lshr_b64 s[84:85], s[84:85], 18
    s_branch HTL_2
HKL_11:
    s_lshr_b64 s[84:85], s[84:85], 20
    s_branch HTL_3
HKL_12:
    s_lshr_b64 s[84:85], s[84:85], 22
    s_branch HTL_4
HKL_13:
    s_lshr_b64 s[84:85], s[84:85], 24
    s_branch HTL_5
HKL_14:
    s_lshr_b64 s[84:85], s[84:85], 26
    s_branch HTL_6
HKL_15:
    s_lshr_b64 s[84:85], s[84:85], 28
    s_branch HTL_7
HKL_0:
    s_lshl_b32 s84, s84, 2
HTL_0:
    s_and_b32 s54, s84, 12
    s_set_gpr_idx_on s54, gpr_idx(SRC2,DST)
    s_lshr_b32 s84, s84, 2
    s_waitcnt vmcnt(5)
    v_mfma_f32_4x4x4_16b_bf16 v[44:47], v[6:7], v[84:85], v[44:47]
    v_mfma_f32_4x4x4_16b_bf16 v[60:63], v[6:7], v[86:87], v[60:63]
    s_and_b32 s54, s84, 12
    s_set_gpr_idx_on s54, gpr_idx(SRC2,DST)
    s_lshr_b32 s84, s84, 2
    s_waitcnt vmcnt(4)
    v_mfma_f32_4x4x4_16b_bf16 v[44:47], v[6:7], v[88:89], v[44:47]
    v_mfma_f32_4x4x4_16b_bf16 v[60:63], v[6:7], v[90:91], v[60:63]
    s_and_b32 s54, s84, 12
    s_set_gpr_idx_on s54, gpr_idx(SRC2,DST)
    s_lshr_b32 s84, s84, 2
    s_waitcnt vmcnt(3)
    v_mfma_f32_4x4x4_16b_bf16 v[44:47], v[6:7], v[92:93], v[44:47]
    v_mfma_f32_4x4x4_16b_bf16 v[60:63], v[6:7], v[94:95], v[60:63]
    s_and_b32 s54, s84, 12
    s_set_gpr_idx_on s54, gpr_idx(SRC2,DST)
    s_lshr_b32 s84, s84, 2
    s_waitcnt vmcnt(2)
    v_mfma_f32_4x4x4_16b_bf16 v[44:47], v[6:7], v[96:97], v[44:47]
    v_mfma_f32_4x4x4_16b_bf16 v[60:63], v[6:7], v[98:99], v[60:63]
    s_and_b32 s54, s84, 12
    s_set_gpr_idx_on s54, gpr_idx(SRC2,DST)
    s_lshr_b32 s84, s84, 2
    s_waitcnt vmcnt(1)
    v_mfma_f32_4x4x4_16b_bf16 v[44:47], v[6:7], v[132:133], v[44:47]
    v_mfma_f32_4x4x4_16b_bf16 v[60:63], v[6:7], v[134:135], v[60:63]
    s_and_b32 s54, s84, 12
    s_set_gpr_idx_on s54, gpr_idx(SRC2,DST)
    s_cmp_eq_u32 s6, 7
    s_waitcnt vmcnt(0)
    v_mfma_f32_4x4x4_16b_bf16 v[44:47], v[6:7], v[136:137], v[44:47]
    v_mfma_f32_4x4x4_16b_bf16 v[60:63], v[6:7], v[138:139], v[60:63]
    s_set_gpr_idx_off
    s_branch K2_FIN2
HKL_1:
    s_lshr_b32 s84, s84, 0
HTL_1:
    s_and_b32 s54, s84, 12
    s_set_gpr_idx_on s54, gpr_idx(SRC2,DST)
    s_lshr_b32 s84, s84, 2
    s_waitcnt vmcnt(5)
    v_mfma_f32_4x4x4_16b_bf16 v[44:47], v[6:7], v[88:89], v[44:47]
    v_mfma_f32_4x4x4_16b_bf16 v[60:63], v[6:7], v[90:91], v[60:63]
    s_and_b32 s54, s84, 12
    s_set_gpr_idx_on s54, gpr_idx(SRC2,DST)
    s_lshr_b32 s84, s84, 2
    s_waitcnt vmcnt(4)
    v_mfma_f32_4x4x4_16b_bf16 v[44:47], v[6:7], v[92:93], v[44:47]
    v_mfma_f32_4x4x4_16b_bf16 v[60:63], v[6:7], v[94:95], v[60:63]
    s_and_b32 s54, s84, 12
    s_set_gpr_idx_on s54, gpr_idx(SRC2,DST)
    s_lshr_b32 s84, s84, 2
    s_waitcnt vmcnt(3)
    v_mfma_f32_4x4x4_16b_bf16 v[44:47], v[6:7], v[96:97], v[44:47]
    v_mfma_f32_4x4x4_16b_bf16 v[60:63], v[6:7], v[98:99], v[60:63]
    s_and_b32 s54, s84, 12
    s_set_gpr_idx_on s54, gpr_idx(SRC2,DST)
    s_lshr_b32 s84, s84, 2
    s_waitcnt vmcnt(2)
    v_mfma_f32_4x4x4_16b_bf16 v[44:47], v[6:7], v[132:133], v[44:47]
    v_mfma_f32_4x4x4_16b_bf16 v[60:63], v[6:7], v[134:135], v[60:63]
    s_and_b32 s54, s84, 12
    s_set_gpr_idx_on s54, gpr_idx(SRC2,DST)
    s_lshr_b32 s84, s84, 2
    s_waitcnt vmcnt(1)
    v_mfma_f32_4x4x4_16b_bf16 v[44:47], v[6:7], v[136:137], v[44:47]
    v_mfma_f32_4x4x4_16b_bf16 v[60:63], v[6:7], v[138:139], v[60:63]
    s_and_b32 s54, s84, 12
    s_set_gpr_idx_on s54, gpr_idx(SRC2,DST)
    s_cmp_eq_u32 s6, 7
    s_waitcnt vmcnt(0)
    v_mfma_f32_4x4x4_16b_bf16 v[44:47], v[6:7], v[76:77], v[44:47]
    v_mfma_f32_4x4x4_16b_bf16 v[60:63], v[6:7], v[78:79], v[60:63]
    s_set_gpr_idx_off
    s_branch K2_FIN2
HKL_2:
    s_lshr_b32 s84, s84, 2
HTL_2:
    s_and_b32 s54, s84, 12
    s_set_gpr_idx_on s54, gpr_idx(SRC2,DST)
    s_lshr_b32 s84, s84, 2
    s_waitcnt vmcnt(5)
    v_mfma_f32_4x4x4_16b_bf16 v[44:47], v[6:7], v[92:93], v[44:47]
    v_mfma_f32_4x4x4_16b_bf16 v[60:63], v[6:7], v[94:95], v[60:63]
    s_and_b32 s54, s84, 12
    s_set_gpr_idx_on s54, gpr_idx(SRC2,DST)
    s_lshr_b32 s84, s84, 2
    s_waitcnt vmcnt(4)
    v_mfma_f32_4x4x4_16b_bf16 v[44:47], v[6:7], v[96:97], v[44:47]
    v_mfma_f32_4x4x4_16b_bf16 v[60:63], v[6:7], v[98:99], v[60:63]
    s_and_b32 s54, s84, 12
    s_set_gpr_idx_on s54, gpr_idx(SRC2,DST)
    s_lshr_b32 s84, s84, 2
    s_waitcnt vmcnt(3)
    v_mfma_f32_4x4x4_16b_bf16 v[44:47], v[6:7], v[132:133], v[44:47]
    v_mfma_f32_4x4x4_16b_bf16 v[60:63], v[6:7], v[134:135], v[60:63]
    s_and_b32 s54, s84, 12
    s_set_gpr_idx_on s54, gpr_idx(SRC2,DST)
    s_lshr_b32 s84, s84, 2
    s_waitcnt vmcnt(2)
    v_mfma_f32_4x4x4_16b_bf16 v[44:47], v[6:7], v[136:137], v[44:47]
    v_mfma_f32_4x4x4_16b_bf16 v[60:63], v[6:7], v[138:139], v[60:63]
    s_and_b32 s54, s84, 12
    s_set_gpr_idx_on s54, gpr_idx(SRC2,DST)
    s_lshr_b32 s84, s84, 2
    s_waitcnt vmcnt(1)
    v_mfma_f32_4x4x4_16b_bf16 v[44:47], v[6:7], v[76:77], v[44:47]
    v_mfma_f32_4x4x4_16b_bf16 v[60:63], v[6:7], v[78:79], v[60:63]
    s_and_b32 s54, s84, 12
    s_set_gpr_idx_on s54, gpr_idx(SRC2,DST)
    s_cmp_eq_u32 s6, 7
    s_waitcnt vmcnt(0)
    v_mfma_f32_4x4x4_16b_bf16 v[44:47], v[6:7], v[80:81], v[44:47]
    v_mfma_f32_4x4x4_16b_bf16 v[60:63], v[6:7], v[82:83], v[60:63]
    s_set_gpr_idx_off
    s_branch K2_FIN2
HKL_3:
    s_lshr_b32 s84, s84, 4
HTL_3:
    s_and_b32 s54, s84, 12
    s_set_gpr_idx_on s54, gpr_idx(SRC2,DST)
    s_lshr_b32 s84, s84, 2
    s_waitcnt vmcnt(5)
    v_mfma_f32_4x4x4_16b_bf16 v[44:47], v[6:7], v[96:97], v[44:47]
    v_mfma_f32_4x4x4_16b_bf16 v[60:63], v[6:7], v[98:99], v[60:63]
    s_and_b32 s54, s84, 12
    s_set_gpr_idx_on s54, gpr_idx(SRC2,DST)
    s_lshr_b32 s84, s84, 2
    s_waitcnt vmcnt(4)
    v_mfma_f32_4x4x4_16b_bf16 v[44:47], v[6:7], v[132:133], v[44:47]
    v_mfma_f32_4x4x4_16b_bf16 v[60:63], v[6:7], v[134:135], v[60:63]
    s_and_b32 s54, s84, 12
    s_set_gpr_idx_on s54, gpr_idx(SRC2,DST)
    s_lshr_b32 s84, s84, 2
    s_waitcnt vmcnt(3)
    v_mfma_f32_4x4x4_16b_bf16 v[44:47], v[6:7], v[136:137], v[44:47]
    v_mfma_f32_4x4x4_16b_bf16 v[60:63], v[6:7], v[138:139], v[60:63]
    s_and_b32 s54, s84, 12
    s_set_gpr_idx_on s54, gpr_idx(SRC2,DST)
    s_lshr_b32 s84, s84, 2
    s_waitcnt vmcnt(2)
    v_mfma_f32_4x4x4_16b_bf16 v[44:47], v[6:7], v[76:77], v[44:47]
    v_mfma_f32_4x4x4_16b_bf16 v[60:63], v[6:7], v[78:79], v[60:63]
    s_and_b32 s54, s84, 12
    s_set_gpr_idx_on s54, gpr_idx(SRC2,DST)
    s_lshr_b32 s84, s84, 2
    s_waitcnt vmcnt(1)
    v_mfma_f32_4x4x4_16b_bf16 v[44:47], v[6:7], v[80:81], v[44:47]
    v_mfma_f32_4x4x4_16b_bf16 v[60:63], v[6:7], v[82:83], v[60:63]
    s_and_b32 s54, s84, 12
    s_set_gpr_idx_on s54, gpr_idx(SRC2,DST)
    s_cmp_eq_u32 s6, 7
    s_waitcnt vmcnt(0)
    v_mfma_f32_4x4x4_16b_bf16 v[44:47], v[6:7], v[84:85], v[44:47]
    v_mfma_f32_4x4x4_16b_bf16 v[60:63], v[6:7], v[86:87], v[60:63]
    s_set_gpr_idx_off
    s_branch K2_FIN2
HKL_4:
    s_lshr_b32 s84, s84, 6
HTL_4:
    s_and_b32 s54, s84, 12
    s_set_gpr_idx_on s54, gpr_idx(SRC2,DST)
    s_lshr_b32 s84, s84, 2
    s_waitcnt vmcnt(5)
    v_mfma_f32_4x4x4_16b_bf16 v[44:47], v[6:7], v[132:133], v[44:47]
    v_mfma_f32_4x4x4_16b_bf16 v[60:63], v[6:7], v[134:135], v[60:63]
    s_and_b32 s54, s84, 12
    s_set_gpr_idx_on s54, gpr_idx(SRC2,DST)
    s_lshr_b32 s84, s84, 2
    s_waitcnt vmcnt(4)
    v_mfma_f32_4x4x4_16b_bf16 v[44:47], v[6:7], v[136:137], v[44:47]
    v_mfma_f32_4x4x4_16b_bf16 v[60:63], v[6:7], v[138:139], v[60:63]
    s_and_b32 s54, s84, 12
    s_set_gpr_idx_on s54, gpr_idx(SRC2,DST)
    s_lshr_b32 s84, s84, 2
    s_waitcnt vmcnt(3)
    v_mfma_f32_4x4x4_16b_bf16 v[44:47], v[6:7], v[76:77], v[44:47]
    v_mfma_f32_4x4x4_16b_bf16 v[60:63], v[6:7], v[78:79], v[60:63]
    s_and_b32 s54, s84, 12
    s_set_gpr_idx_on s54, gpr_idx(SRC2,DST)
    s_lshr_b32 s84, s84, 2
    s_waitcnt vmcnt(2)
    v_mfma_f32_4x4x4_16b_bf16 v[44:47], v[6:7], v[80:81], v[44:47]
    v_mfma_f32_4x4x4_16b_bf16 v[60:63], v[6:7], v[82:83], v[60:63]
    s_and_b32 s54, s84, 12
    s_set_gpr_idx_on s54, gpr_idx(SRC2,DST)
    s_lshr_b32 s84, s84, 2
    s_waitcnt vmcnt(1)
    v_mfma_f32_4x4x4_16b_bf16 v[44:47], v[6:7], v[84:85], v[44:47]
    v_mfma_f32_4x4x4_16b_bf16 v[60:63], v[6:7], v[86:87], v[60:63]
    s_and_b32 s54, s84, 12
    s_set_gpr_idx_on s54, gpr_idx(SRC2,DST)
    s_cmp_eq_u32 s6, 7
    s_waitcnt vmcnt(0)
    v_mfma_f32_4x4x4_16b_bf16 v[44:47], v[6:7], v[88:89], v[44:47]
    v_mfma_f32_4x4x4_16b_bf16 v[60:63], v[6:7], v[90:91], v[60:63]
    s_set_gpr_idx_off
    s_branch K2_FIN2
HKL_5:
    s_lshr_b32 s84, s84, 8
HTL_5:
    s_and_b32 s54, s84, 12
    s_set_gpr_idx_on s54, gpr_idx(SRC2,DST)
    s_lshr_b32 s84, s84, 2
    s_waitcnt vmcnt(5)
    v_mfma_f32_4x4x4_16b_bf16 v[44:47], v[6:7], v[136:137], v[44:47]
    v_mfma_f32_4x4x4_16b_bf16 v[60:63], v[6:7], v[138:139], v[60:63]
    s_and_b32 s54, s84, 12
    s_set_gpr_idx_on s54, gpr_idx(SRC2,DST)
    s_lshr_b32 s84, s84, 2
    s_waitcnt vmcnt(4)
    v_mfma_f32_4x4x4_16b_bf16 v[44:47], v[6:7], v[76:77], v[44:47]
    v_mfma_f32_4x4x4_16b_bf16 v[60:63], v[6:7], v[78:79], v[60:63]
    s_and_b32 s54, s84, 12
    s_set_gpr_idx_on s54, gpr_idx(SRC2,DST)
    s_lshr_b32 s84, s84, 2
    s_waitcnt vmcnt(3)
    v_mfma_f32_4x4x4_16b_bf16 v[44:47], v[6:7], v[80:81], v[44:47]
    v_mfma_f32_4x4x4_16b_bf16 v[60:63], v[6:7], v[82:83], v[60:63]
    s_and_b32 s54, s84, 12
    s_set_gpr_idx_on s54, gpr_idx(SRC2,DST)
    s_lshr_b32 s84, s84, 2
    s_waitcnt vmcnt(2)
    v_mfma_f32_4x4x4_16b_bf16 v[44:47], v[6:7], v[84:85], v[44:47]
    v_mfma_f32_4x4x4_16b_bf16 v[60:63], v[6:7], v[86:87], v[60:63]
    s_and_b32 s54, s84, 12
    s_set_gpr_idx_on s54, gpr_idx(SRC2,DST)
    s_lshr_b32 s84, s84, 2
    s_waitcnt vmcnt(1)
    v_mfma_f32_4x4x4_16b_bf16 v[44:47], v[6:7], v[88:89], v[44:47]
    v_mfma_f32_4x4x4_16b_bf16 v[60:63], v[6:7], v[90:91], v[60:63]
    s_and_b32 s54, s84, 12
    s_set_gpr_idx_on s54, gpr_idx(SRC2,DST)
    s_cmp_eq_u32 s6, 7
    s_waitcnt vmcnt(0)
    v_mfma_f32_4x4x4_16b_bf16 v[44:47], v[6:7], v[92:93], v[44:47]
    v_mfma_f32_4x4x4_16b_bf16 v[60:63], v[6:7], v[94:95], v[60:63]
    s_set_gpr_idx_off
    s_branch K2_FIN2
HKL_6:
    s_lshr_b32 s84, s84, 10
HTL_6:
    s_and_b32 s54, s84, 12
    s_set_gpr_idx_on s54, gpr_idx(SRC2,DST)
    s_lshr_b32 s84, s84, 2
    s_waitcnt vmcnt(5)
    v_mfma_f32_4x4x4_16b_bf16 v[44:47], v[6:7], v[76:77], v[44:47]
    v_mfma_f32_4x4x4_16b_bf16 v[60:63], v[6:7], v[78:79], v[60:63]
    s_and_b32 s54, s84, 12
    s_set_gpr_idx_on s54, gpr_idx(SRC2,DST)
    s_lshr_b32 s84, s84, 2
    s_waitcnt vmcnt(4)
    v_mfma_f32_4x4x4_16b_bf16 v[44:47], v[6:7], v[80:81], v[44:47]
    v_mfma_f32_4x4x4_16b_bf16 v[60:63], v[6:7], v[82:83], v[60:63]
    s_and_b32 s54, s84, 12
    s_set_gpr_idx_on s54, gpr_idx(SRC2,DST)
    s_lshr_b32 s84, s84, 2
    s_waitcnt vmcnt(3)
    v_mfma_f32_4x4x4_16b_bf16 v[44:47], v[6:7], v[84:85], v[44:47]
    v_mfma_f32_4x4x4_16b_bf16 v[60:63], v[6:7], v[86:87], v[60:63]
    s_and_b32 s54, s84, 12
    s_set_gpr_idx_on s54, gpr_idx(SRC2,DST)
    s_lshr_b32 s84, s84, 2
    s_waitcnt vmcnt(2)
    v_mfma_f32_4x4x4_16b_bf16 v[44:47], v[6:7], v[88:89], v[44:47]
    v_mfma_f32_4x4x4_16b_bf16 v[60:63], v[6:7], v[90:91], v[60:63]
    s_and_b32 s54, s84, 12
    s_set_gpr_idx_on s54, gpr_idx(SRC2,DST)
    s_lshr_b32 s84, s84, 2
    s_waitcnt vmcnt(1)
    v_mfma_f32_4x4x4_16b_bf16 v[44:47], v[6:7], v[92:93], v[44:47]
    v_mfma_f32_4x4x4_16b_bf16 v[60:63], v[6:7], v[94:95], v[60:63]
    s_and_b32 s54, s84, 12
    s_set_gpr_idx_on s54, gpr_idx(SRC2,DST)
    s_cmp_eq_u32 s6, 7
    s_waitcnt vmcnt(0)
    v_mfma_f32_4x4x4_16b_bf16 v[44:47], v[6:7], v[96:97], v[44:47]
    v_mfma_f32_4x4x4_16b_bf16 v[60:63], v[6:7], v[98:99], v[60:63]
    s_set_gpr_idx_off
    s_branch K2_FIN2
HKL_7:
    s_lshr_b32 s84, s84, 12
HTL_7:
    s_and_b32 s54, s84, 12
    s_set_gpr_idx_on s54, gpr_idx(SRC2,DST)
    s_lshr_b32 s84, s84, 2
    s_waitcnt vmcnt(5)
    v_mfma_f32_4x4x4_16b_bf16 v[44:47], v[6:7], v[80:81], v[44:47]
    v_mfma_f32_4x4x4_16b_bf16 v[60:63], v[6:7], v[82:83], v[60:63]
    s_and_b32 s54, s84, 12
    s_set_gpr_idx_on s54, gpr_idx(SRC2,DST)
    s_lshr_b32 s84, s84, 2
    s_waitcnt vmcnt(4)
    v_mfma_f32_4x4x4_16b_bf16 v[44:47], v[6:7], v[84:85], v[44:47]
    v_mfma_f32_4x4x4_16b_bf16 v[60:63], v[6:7], v[86:87], v[60:63]
    s_and_b32 s54, s84, 12
    s_set_gpr_idx_on s54, gpr_idx(SRC2,DST)
    s_lshr_b32 s84, s84, 2
    s_waitcnt vmcnt(3)
    v_mfma_f32_4x4x4_16b_bf16 v[44:47], v[6:7], v[88:89], v[44:47]
    v_mfma_f32_4x4x4_16b_bf16 v[60:63], v[6:7], v[90:91], v[60:63]
    s_and_b32 s54, s84, 12
    s_set_gpr_idx_on s54, gpr_idx(SRC2,DST)
    s_lshr_b32 s84, s84, 2
    s_waitcnt vmcnt(2)
    v_mfma_f32_4x4x4_16b_bf16 v[44:47], v[6:7], v[92:93], v[44:47]
    v_mfma_f32_4x4x4_16b_bf16 v[60:63], v[6:7], v[94:95], v[60:63]
    s_and_b32 s54, s84, 12
    s_set_gpr_idx_on s54, gpr_idx(SRC2,DST)
    s_lshr_b32 s84, s84, 2
    s_waitcnt vmcnt(1)
    v_mfma_f32_4x4x4_16b_bf16 v[44:47], v[6:7], v[96:97], v[44:47]
    v_mfma_f32_4x4x4_16b_bf16 v[60:63], v[6:7], v[98:99], v[60:63]
    s_and_b32 s54, s84, 12
    s_set_gpr_idx_on s54, gpr_idx(SRC2,DST)
    s_cmp_eq_u32 s6, 7
    s_waitcnt vmcnt(0)
    v_mfma_f32_4x4x4_16b_bf16 v[44:47], v[6:7], v[132:133], v[44:47]
    v_mfma_f32_4x4x4_16b_bf16 v[60:63], v[6:7], v[134:135], v[60:63]
    s_set_gpr_idx_off
    s_branch K2_FIN2
K2_SLOW:
    s_waitcnt vmcnt(0)
    s_mov_b32 s84, 0
SL_SEG:
    s_lshl_b32 s54, s84, 10
    s_lshl_b32 s55, s4, 2
    s_add_u32 s54, s54, s55
    s_add_u32 s54, s54, 3211264
    buffer_load_dword v132, v175, s[24:27], s54 offen sc1
    s_mul_i32 s86, s84, 3200
    s_waitcnt vmcnt(0)
    v_readfirstlane_b32 s85, v132
    s_and_b32 s87, s85, 0xffff
    s_lshr_b32 s85, s85, 16
    s_add_u32 s86, s86, s87
    s_lshl_b32 s86, s86, 2
SL_BATCH:
    s_cmp_eq_u32 s85, 0
    s_cbranch_scc1 SL_NEXT
    v_lshlrev_b32 v134, 2, v1
    buffer_load_dword v132, v134, s[24:27], s86 offen sc1
    s_min_u32 s87, s85, 64
    s_sub_u32 s85, s85, s87
    s_add_u32 s86, s86, 256
    v_mov_b32 v133, 2130706432
    s_waitcnt vmcnt(0)
SL_FOUR:
    v_mov_b32 v3, v133
    s_mov_b32 s92, 0
SL_FIND0:
    s_cmp_eq_u32 s87, 0
    s_cbranch_scc1 SL_GO0
    s_sub_u32 s87, s87, 1
    v_readlane_b32 s89, v132, s87
    s_bfe_u32 s88, s89, 0x80005
    s_mov_b32 s92, 0
    v_cmp_eq_u32 vcc, s88, v24
    s_cbranch_vccnz SL_HIT0
    s_mov_b32 s92, 4
    v_cmp_eq_u32 vcc, s88, v25
    s_cbranch_vccnz SL_HIT0
    s_mov_b32 s92, 8
    v_cmp_eq_u32 vcc, s88, v26
    s_cbranch_vccnz SL_HIT0
    s_mov_b32 s92, 12
    v_cmp_eq_u32 vcc, s88, v27
    s_cbranch_vccnz SL_HIT0
    s_branch SL_FIND0
SL_HIT0:
    s_lshr_b32 s89, s89, 15
    s_lshl_b32 s89, s89, 7
    v_xor_b32 v3, s89, v0
    v_cndmask_b32 v3, v133, v3, vcc
SL_GO0:
    buffer_load_dwordx4 v[76:79], v3, s[16:19], 0 offen sc1
    v_mov_b32 v3, v133
    s_mov_b32 s93, 0
SL_FIND1:
    s_cmp_eq_u32 s87, 0
    s_cbranch_scc1 SL_GO1
    s_sub_u32 s87, s87, 1
    v_readlane_b32 s89, v132, s87
    s_bfe_u32 s88, s89, 0x80005
    s_mov_b32 s93, 0
    v_cmp_eq_u32 vcc, s88, v24
    s_cbranch_vccnz SL_HIT1
    s_mov_b32 s93, 4
    v_cmp_eq_u32 vcc, s88, v25
    s_cbranch_vccnz SL_HIT1
    s_mov_b32 s93, 8
    v_cmp_eq_u32 vcc, s88, v26
    s_cbranch_vccnz SL_HIT1
    s_mov_b32 s93, 12
    v_cmp_eq_u32 vcc, s88, v27
    s_cbranch_vccnz SL_HIT1
    s_branch SL_FIND1
SL_HIT1:
    s_lshr_b32 s89, s89, 15
    s_lshl_b32 s89, s89, 7
    v_xor_b32 v3, s89, v0
    v_cndmask_b32 v3, v133, v3, vcc
SL_GO1:
    buffer_load_dwordx4 v[80:83], v3, s[16:19], 0 offen sc1
    v_mov_b32 v3, v133
    s_mov_b32 s94, 0
SL_FIND2:
    s_cmp_eq_u32 s87, 0
    s_cbranch_scc1 SL_GO2
    s_sub_u32 s87, s87, 1
    v_readlane_b32 s89, v132, s87
    s_bfe_u32 s88, s89, 0x80005
    s_mov_b32 s94, 0
    v_cmp_eq_u32 vcc, s88, v24
    s_cbranch_vccnz SL_HIT2
    s_mov_b32 s94, 4
    v_cmp_eq_u32 vcc, s88, v25
    s_cbranch_vccnz SL_HIT2
    s_mov_b32 s94, 8
    v_cmp_eq_u32 vcc, s88, v26
    s_cbranch_vccnz SL_HIT2
    s_mov_b32 s94, 12
    v_cmp_eq_u32 vcc, s88, v27
    s_cbranch_vccnz SL_HIT2
    s_branch SL_FIND2
SL_HIT2:
    s_lshr_b32 s89, s89, 15
    s_lshl_b32 s89, s89, 7
    v_xor_b32 v3, s89, v0
    v_cndmask_b32 v3, v133, v3, vcc
SL_GO2:
    buffer_load_dwordx4 v[84:87], v3, s[16:19], 0 offen sc1
    v_mov_b32 v3, v133
    s_mov_b32 s95, 0
SL_FIND3:
    s_cmp_eq_u32 s87, 0
    s_cbranch_scc1 SL_GO3
    s_sub_u32 s87, s87, 1
    v_readlane_b32 s89, v132, s87
    s_bfe_u32 s88, s89, 0x80005
    s_mov_b32 s95, 0
    v_cmp_eq_u32 vcc, s88, v24
    s_cbranch_vccnz SL_HIT3
    s_mov_b32 s95, 4
    v_cmp_eq_u32 vcc, s88, v25
    s_cbranch_vccnz SL_HIT3
    s_mov_b32 s95, 8
    v_cmp_eq_u32 vcc, s88, v26
    s_cbranch_vccnz SL_HIT3
    s_mov_b32 s95, 12
    v_cmp_eq_u32 vcc, s88, v27
    s_cbranch_vccnz SL_HIT3
    s_branch SL_FIND3
SL_HIT3:
    s_lshr_b32 s89, s89, 15
    s_lshl_b32 s89, s89, 7
    v_xor_b32 v3, s89, v0
    v_cndmask_b32 v3, v133, v3, vcc
SL_GO3:
    buffer_load_dwordx4 v[88:91], v3, s[16:19], 0 offen sc1
    s_set_gpr_idx_on s92, gpr_idx(SRC2,DST)
    s_waitcnt vmcnt(3)
    v_mfma_f32_4x4x4_16b_bf16 v[44:47], v[6:7], v[76:77], v[44:47]
    v_mfma_f32_4x4x4_16b_bf16 v[60:63], v[6:7], v[78:79], v[60:63]
    s_set_gpr_idx_on s93, gpr_idx(SRC2,DST)
    s_waitcnt vmcnt(2)
    v_mfma_f32_4x4x4_16b_bf16 v[44:47], v[6:7], v[80:81], v[44:47]
    v_mfma_f32_4x4x4_16b_bf16 v[60:63], v[6:7], v[82:83], v[60:63]
    s_set_gpr_idx_on s94, gpr_idx(SRC2,DST)
    s_waitcnt vmcnt(1)
    v_mfma_f32_4x4x4_16b_bf16 v[44:47], v[6:7], v[84:85], v[44:47]
    v_mfma_f32_4x4x4_16b_bf16 v[60:63], v[6:7], v[86:87], v[60:63]
    s_set_gpr_idx_on s95, gpr_idx(SRC2,DST)
    s_waitcnt vmcnt(0)
    v_mfma_f32_4x4x4_16b_bf16 v[44:47], v[6:7], v[88:89], v[44:47]
    v_mfma_f32_4x4x4_16b_bf16 v[60:63], v[6:7], v[90:91], v[60:63]
    s_set_gpr_idx_off
    s_cmp_lg_u32 s87, 0
    s_cbranch_scc1 SL_FOUR
    s_branch SL_BATCH
SL_NEXT:
    s_add_u32 s84, s84, 1
    s_cmp_lt_u32 s84, 250
    s_cbranch_scc1 SL_SEG
    s_waitcnt vmcnt(0)
    s_branch K2_FIN
K2_FINAL:
    s_setprio 2
    ds_read_b128 v[76:79], v176 offset:0
    ds_read_b128 v[80:83], v177 offset:0
    ds_read_b128 v[84:87], v176 offset:2048
    ds_read_b128 v[88:91], v177 offset:2048
    v_mov_b32 v168, 2130706432
    s_mov_b32 s69, 8192
    s_waitcnt lgkmcnt(0)
F_LOOP:
    s_waitcnt lgkmcnt(14)
    v_mfma_f32_16x16x32_bf16 v[60:63], v[192:195], v[84:87], 0
    ds_read_b64_tr_b16 v[2:3], v180 offset:0
    ds_read_b64_tr_b16 v[6:7], v181 offset:0
    v_mfma_f32_16x16x32_bf16 v[64:67], v[200:203], v[84:87], 0
    ds_read_b64_tr_b16 v[10:11], v182 offset:0
    ds_read_b64_tr_b16 v[18:19], v183 offset:0
    v_mfma_f32_16x16x32_bf16 v[68:71], v[208:211], v[84:87], 0
    v_cndmask_b32 v92, v92, v93, s[70:71]
    v_cndmask_b32 v94, v94, v95, s[70:71]
    v_cndmask_b32 v96, v96, v97, s[70:71]
    v_mfma_f32_16x16x32_bf16 v[72:75], v[216:219], v[84:87], 0
    s_waitcnt lgkmcnt(14)
    v_cndmask_b32 v98, v98, v99, s[70:71]
    v_cndmask_b32 v92, v92, v94, s[72:73]
    v_cndmask_b32 v96, v96, v98, s[72:73]
    v_mfma_f32_16x16x32_bf16 v[60:63], v[196:199], v[88:91], v[60:63]
    ds_read_b128 v[84:87], v178 offset:2048
    v_permlane32_swap_b32 v92, v96
    v_mfma_f32_16x16x32_bf16 v[64:67], v[204:207], v[88:91], v[64:67]
    v_cndmask_b32 v96, v92, v96, s[76:77]
    v_cndmask_b32 v152, v148, v152, s[78:79]
    v_mov_b32 v97, v96
    v_mfma_f32_16x16x32_bf16 v[68:71], v[212:215], v[88:91], v[68:71]
    s_nop 0
    v_permlane16_swap_b32 v96, v97
    v_cndmask_b32 v153, v149, v153, s[78:79]
    v_mfma_f32_16x16x32_bf16 v[72:75], v[220:223], v[88:91], v[72:75]
    v_cndmask_b32 v96, v96, v97, s[74:75]
    v_fma_f32 v99, v152, s66, v153
    v_fma_f32 v96, -v152, v152, v96
    v_mfma_f32_16x16x32_bf16 v[44:47], v[192:195], v[76:79], 0
    ds_read_b128 v[88:91], v179 offset:2048
    v_fma_f32 v96, |v96|, s67, v170
    v_cvt_pk_bf16_f32 v140, v60, v61
    v_mfma_f32_16x16x32_bf16 v[48:51], v[200:203], v[76:79], 0
    v_rsq_f32 v96, v96
    v_cvt_pk_bf16_f32 v141, v62, v63
    v_mfma_f32_16x16x32_bf16 v[52:55], v[208:211], v[76:79], 0
    v_mul_f32 v96, v96, v99
    v_cvt_pk_bf16_f32 v142, v64, v65
    v_cvt_pk_bf16_f32 v143, v66, v67
    v_mfma_f32_16x16x32_bf16 v[56:59], v[216:219], v[76:79], 0
    ds_read_b64 v[98:99], v186 offset:128
    v_max_f32_dpp v97, v96, v96 quad_perm:[1,0,3,2] row_mask:0xf bank_mask:0xf
    v_cvt_pk_bf16_f32 v144, v68, v69
    v_mfma_f32_16x16x32_bf16 v[44:47], v[196:199], v[80:83], v[44:47]
    v_max_f32_dpp v97, v97, v97 quad_perm:[2,3,0,1] row_mask:0xf bank_mask:0xf
    v_cvt_pk_bf16_f32 v145, v70, v71
    v_cvt_pk_bf16_f32 v146, v72, v73
    v_mfma_f32_16x16x32_bf16 v[48:51], v[204:207], v[80:83], v[48:51]
    v_max_f32_dpp v97, v97, v97 row_half_mirror row_mask:0xf bank_mask:0xf
    v_cvt_pk_bf16_f32 v147, v74, v75
    v_sub_f32 v96, v96, v97
    v_mfma_f32_16x16x32_bf16 v[52:55], v[212:215], v[80:83], v[52:55]
    v_exp_f32 v96, v96
    v_cvt_pk_bf16_f32 v132, v44, v45
    v_mfma_f32_16x16x32_bf16 v[56:59], v[220:223], v[80:83], v[56:59]
    s_waitcnt lgkmcnt(2)
    v_add_f32_dpp v97, v96, v96 quad_perm:[1,0,3,2] row_mask:0xf bank_mask:0xf
    v_cvt_pk_bf16_f32 v133, v46, v47
    v_cvt_pk_bf16_f32 v134, v48, v49
    v_mfma_f32_16x16x32_bf16 v[152:155], v[84:87], v[140:143], 0
    v_cvt_pk_bf16_f32 v135, v50, v51
    v_add_f32_dpp v97, v97, v97 quad_perm:[2,3,0,1] row_mask:0xf bank_mask:0xf
    v_cvt_pk_bf16_f32 v136, v52, v53
    v_mfma_f32_16x16x32_bf16 v[148:151], v[76:79], v[132:135], 0
    ds_read2_b32 v[140:141], v171 offset0:0 offset1:0
    v_cvt_pk_bf16_f32 v137, v54, v55
    v_cvt_pk_bf16_f32 v138, v56, v57
    s_waitcnt lgkmcnt(2)
    v_mfma_f32_16x16x32_bf16 v[152:155], v[88:91], v[144:147], v[152:155]
    ds_read2_b32 v[142:143], v171 offset0:0 offset1:0
    v_cvt_pk_bf16_f32 v139, v58, v59
    v_add_f32_dpp v97, v97, v97 row_half_mirror row_mask:0xf bank_mask:0xf
    v_mfma_f32_16x16x32_bf16 v[44:47], v[76:79], v[224:227], 0
    ds_read2_b32 v[144:145], v171 offset0:16 offset1:16
    v_rcp_f32 v97, v97
    v_mfma_f32_16x16x32_bf16 v[148:151], v[80:83], v[136:139], v[148:151]
    ds_read2_b32 v[146:147], v171 offset0:16 offset1:16
    v_mul_f32 v96, v96, v97
    v_cvt_pk_bf16_f32 v96, v96, v96
    v_mfma_f32_16x16x32_bf16 v[48:51], v[76:79], v[232:235], 0
    ds_write_b16 v187, v96
    ds_read_b64 v[92:93], v190 offset:0
    v_mfma_f32_16x16x32_bf16 v[60:63], v[84:87], v[224:227], 0
    ds_read_b64 v[94:95], v191 offset:32
    v_cndmask_b32 v148, v152, v148, s[64:65]
    v_cndmask_b32 v149, v153, v149, s[64:65]
    v_cndmask_b32 v150, v154, v150, s[64:65]
    v_cndmask_b32 v151, v155, v151, s[64:65]
    v_max3_f32 v152, v148, v149, v150
    v_mfma_f32_16x16x32_bf16 v[64:67], v[84:87], v[232:235], 0
    v_max_f32 v152, v152, v151
    v_mov_b32 v153, v152
    v_mfma_f32_16x16x32_bf16 v[52:55], v[76:79], v[240:243], 0
    s_nop 0
    v_permlane16_swap_b32 v152, v153
    v_mfma_f32_16x16x32_bf16 v[68:71], v[84:87], v[240:243], 0
    v_max_f32 v152, v152, v153
    v_sub_f32 v148, v148, v152
    v_mfma_f32_16x16x32_bf16 v[56:59], v[76:79], v[248:251], 0
    s_waitcnt lgkmcnt(0)
    v_sub_f32 v149, v149, v152
    v_sub_f32 v150, v150, v152
    v_sub_f32 v151, v151, v152
    v_mfma_f32_16x16x32_bf16 v[28:31], v[20:23], v[92:95], v[28:31]
    ds_read_b128 v[76:79], v176 offset:4096
    v_exp_f32 v148, v148
    v_mfma_f32_16x16x32_bf16 v[32:35], v[24:27], v[92:95], v[32:35]
    ds_read_b64_tr_b16 v[22:23], v180 offset:2048
    v_exp_f32 v149, v149
    v_mfma_f32_16x16x32_bf16 v[36:39], v[156:159], v[92:95], v[36:39]
    ds_read_b64_tr_b16 v[26:27], v181 offset:2048
    v_exp_f32 v150, v150
    v_mfma_f32_16x16x32_bf16 v[40:43], v[172:175], v[92:95], v[40:43]
    ds_read_b64_tr_b16 v[158:159], v182 offset:2048
    v_exp_f32 v151, v151
    v_mfma_f32_16x16x32_bf16 v[44:47], v[80:83], v[228:231], v[44:47]
    ds_read_b64 v[94:95], v186 offset:0
    v_add_f32 v152, v148, v149
    v_add_f32 v153, v150, v151
    v_mfma_f32_16x16x32_bf16 v[48:51], v[80:83], v[236:239], v[48:51]
    ds_read_b64_tr_b16 v[174:175], v183 offset:2048
    v_add_f32 v152, v152, v153
    v_cvt_pk_bf16_f32 v28, v28, v29
    v_mfma_f32_16x16x32_bf16 v[72:75], v[84:87], v[248:251], 0
    v_mov_b32 v153, v152
    v_cvt_pk_bf16_f32 v0, v44, v45
    v_cvt_pk_bf16_f32 v1, v46, v47
    v_mfma_f32_16x16x32_bf16 v[60:63], v[88:91], v[228:231], v[60:63]
    ds_read_b128 v[84:87], v176 offset:6144
    v_permlane16_swap_b32 v152, v153
    v_mfma_f32_16x16x32_bf16 v[64:67], v[88:91], v[236:239], v[64:67]
    v_add_f32 v152, v152, v153
    v_cvt_pk_bf16_f32 v4, v48, v49
    v_rcp_f32 v152, v152
    v_mfma_f32_16x16x32_bf16 v[52:55], v[80:83], v[244:247], v[52:55]
    v_mul_f32 v148, v148, v152
    v_mul_f32 v149, v149, v152
    v_mul_f32 v150, v150, v152
    v_mfma_f32_16x16x32_bf16 v[56:59], v[80:83], v[252:255], v[56:59]
    v_mul_f32 v151, v151, v152
    v_cvt_pk_bf16_f32 v148, v148, v149
    v_cvt_pk_bf16_f32 v149, v150, v151
    v_mfma_f32_16x16x32_bf16 v[68:71], v[88:91], v[244:247], v[68:71]
    ds_read_b128 v[80:83], v177 offset:4096
    v_cvt_pk_bf16_f32 v5, v50, v51
    v_cvt_pk_bf16_f32 v20, v60, v61
    v_mfma_f32_16x16x32_bf16 v[72:75], v[88:91], v[252:255], v[72:75]
    v_cvt_pk_bf16_f32 v21, v62, v63
    v_cvt_pk_bf16_f32 v24, v64, v65
    v_cvt_pk_bf16_f32 v25, v66, v67
    v_cndmask_b32 v92, 0, v148, s[64:65]
    v_cndmask_b32 v93, 0, v149, s[64:65]
    v_cndmask_b32 v96, v148, 0, s[64:65]
    v_cndmask_b32 v97, v149, 0, s[64:65]
    s_waitcnt lgkmcnt(3)
    v_mfma_f32_16x16x32_bf16 v[44:47], v[0:3], v[92:95], v[140:143]
    ds_read_b128 v[88:91], v177 offset:6144
    v_cvt_pk_bf16_f32 v8, v52, v53
    v_cvt_pk_bf16_f32 v9, v54, v55
    v_mfma_f32_16x16x32_bf16 v[48:51], v[4:7], v[92:95], v[140:143]
    ds_read_b64_tr_b16 v[2:3], v180 offset:4096
    v_cvt_pk_bf16_f32 v16, v56, v57
    v_cvt_pk_bf16_f32 v17, v58, v59
    v_mfma_f32_16x16x32_bf16 v[60:63], v[20:23], v[96:99], v[144:147]
    ds_read_b64_tr_b16 v[6:7], v181 offset:4096
    v_cvt_pk_bf16_f32 v156, v68, v69
    v_cvt_pk_bf16_f32 v157, v70, v71
    v_mfma_f32_16x16x32_bf16 v[64:67], v[24:27], v[96:99], v[144:147]
    v_cvt_pk_bf16_f32 v172, v72, v73
    v_cvt_pk_bf16_f32 v173, v74, v75
    v_cvt_pk_bf16_f32 v132, v44, v45
    v_mfma_f32_16x16x32_bf16 v[52:55], v[8:11], v[92:95], v[140:143]
    v_cvt_pk_bf16_f32 v133, v46, v47
    v_cvt_pk_bf16_f32 v134, v48, v49
    v_cvt_pk_bf16_f32 v135, v50, v51
    v_mfma_f32_16x16x32_bf16 v[56:59], v[16:19], v[92:95], v[140:143]
    ds_write_b128 v184, v[132:135] offset:0
    v_mfma_f32_16x16x32_bf16 v[68:71], v[156:159], v[96:99], v[144:147]
    ds_read_b64_tr_b16 v[10:11], v182 offset:4096
    v_cvt_pk_bf16_f32 v140, v60, v61
    v_cvt_pk_bf16_f32 v141, v62, v63
    s_waitcnt lgkmcnt(7)
    v_mfma_f32_16x16x32_bf16 v[72:75], v[172:175], v[96:99], v[144:147]
    ds_read_b64_tr_b16 v[18:19], v183 offset:4096
    v_cvt_pk_bf16_f32 v142, v64, v65
    v_cvt_pk_bf16_f32 v143, v66, v67
    v_mfma_f32_16x16x32_bf16 v[92:95], v[132:135], v[132:135], 0
    ds_write_b128 v184, v[140:143] offset:2048
    v_mfma_f32_16x16x32_bf16 v[96:99], v[140:143], v[140:143], 0
    v_cvt_pk_bf16_f32 v136, v52, v53
    v_cvt_pk_bf16_f32 v137, v54, v55
    v_cvt_pk_bf16_f32 v138, v56, v57
    v_mfma_f32_16x16x32_bf16 v[148:151], v[160:163], v[132:135], 0
    v_cvt_pk_bf16_f32 v139, v58, v59
    v_cvt_pk_bf16_f32 v144, v68, v69
    v_cvt_pk_bf16_f32 v145, v70, v71
    v_mfma_f32_16x16x32_bf16 v[92:95], v[136:139], v[136:139], v[92:95]
    ds_write_b128 v185, v[136:139] offset:0
    v_mfma_f32_16x16x32_bf16 v[152:155], v[160:163], v[140:143], 0
    ds_read_b64_tr_b16 v[20:21], v180 offset:0
    v_cvt_pk_bf16_f32 v146, v72, v73
    v_cvt_pk_bf16_f32 v147, v74, v75
    v_mfma_f32_16x16x32_bf16 v[148:151], v[164:167], v[136:139], v[148:151]
    ds_write_b128 v185, v[144:147] offset:2048
    v_mfma_f32_16x16x32_bf16 v[96:99], v[144:147], v[144:147], v[96:99]
    ds_read_b64_tr_b16 v[24:25], v181 offset:0
    v_cndmask_b32 v92, v92, v93, s[70:71]
    v_cndmask_b32 v94, v94, v95, s[70:71]
    v_mfma_f32_16x16x32_bf16 v[152:155], v[164:167], v[144:147], v[152:155]
    ds_read_b64_tr_b16 v[156:157], v182 offset:0
    v_cndmask_b32 v92, v92, v94, s[72:73]
    v_cvt_pk_bf16_f32 v29, v30, v31
    s_waitcnt lgkmcnt(13)
    v_mfma_f32_16x16x32_bf16 v[60:63], v[192:195], v[84:87], 0
    ds_read_b64_tr_b16 v[172:173], v183 offset:0
    v_cndmask_b32 v96, v96, v97, s[70:71]
    v_cndmask_b32 v98, v98, v99, s[70:71]
    v_mfma_f32_16x16x32_bf16 v[64:67], v[200:203], v[84:87], 0
    ds_read_b64_tr_b16 v[22:23], v180 offset:2048
    v_cndmask_b32 v96, v96, v98, s[72:73]
    v_cndmask_b32 v152, v148, v152, s[78:79]
    v_mfma_f32_16x16x32_bf16 v[68:71], v[208:211], v[84:87], 0
    ds_read_b64_tr_b16 v[26:27], v181 offset:2048
    v_permlane32_swap_b32 v92, v96
    v_mfma_f32_16x16x32_bf16 v[72:75], v[216:219], v[84:87], 0
    ds_read_b64_tr_b16 v[158:159], v182 offset:2048
    v_cndmask_b32 v96, v92, v96, s[76:77]
    v_cndmask_b32 v153, v149, v153, s[78:79]
    s_waitcnt lgkmcnt(14)
    v_mfma_f32_16x16x32_bf16 v[60:63], v[196:199], v[88:91], v[60:63]
    ds_read_b128 v[84:87], v178 offset:6144
    v_mov_b32 v97, v96
    v_fma_f32 v99, v152, s66, v153
    v_mfma_f32_16x16x32_bf16 v[64:67], v[204:207], v[88:91], v[64:67]
    ds_read_b64_tr_b16 v[174:175], v183 offset:2048
    v_permlane16_swap_b32 v96, v97
    v_mfma_f32_16x16x32_bf16 v[68:71], v[212:215], v[88:91], v[68:71]
    v_cndmask_b32 v96, v96, v97, s[74:75]
    v_cvt_pk_bf16_f32 v140, v60, v61
    v_fma_f32 v96, -v152, v152, v96
    v_mfma_f32_16x16x32_bf16 v[72:75], v[220:223], v[88:91], v[72:75]
    v_fma_f32 v96, |v96|, s67, v170
    v_cvt_pk_bf16_f32 v141, v62, v63
    v_rsq_f32 v96, v96
    v_mfma_f32_16x16x32_bf16 v[44:47], v[192:195], v[76:79], 0
    ds_read_b128 v[88:91], v179 offset:6144
    v_mul_f32 v96, v96, v99
    v_cvt_pk_bf16_f32 v142, v64, v65
    v_mfma_f32_16x16x32_bf16 v[48:51], v[200:203], v[76:79], 0
    ds_read_b64 v[98:99], v186 offset:384
    v_max_f32_dpp v97, v96, v96 quad_perm:[1,0,3,2] row_mask:0xf bank_mask:0xf
    v_cvt_pk_bf16_f32 v143, v66, v67
    v_mfma_f32_16x16x32_bf16 v[52:55], v[208:211], v[76:79], 0
    v_max_f32_dpp v97, v97, v97 quad_perm:[2,3,0,1] row_mask:0xf bank_mask:0xf
    v_cvt_pk_bf16_f32 v144, v68, v69
    v_cvt_pk_bf16_f32 v145, v70, v71
    v_mfma_f32_16x16x32_bf16 v[56:59], v[216:219], v[76:79], 0
    v_max_f32_dpp v97, v97, v97 row_half_mirror row_mask:0xf bank_mask:0xf
    v_cvt_pk_bf16_f32 v146, v72, v73
    v_sub_f32 v96, v96, v97
    v_mfma_f32_16x16x32_bf16 v[44:47], v[196:199], v[80:83], v[44:47]
    v_exp_f32 v96, v96
    v_cvt_pk_bf16_f32 v147, v74, v75
    v_mfma_f32_16x16x32_bf16 v[48:51], v[204:207], v[80:83], v[48:51]
    v_add_f32_dpp v97, v96, v96 quad_perm:[1,0,3,2] row_mask:0xf bank_mask:0xf
    v_cvt_pk_bf16_f32 v30, v32, v33
    v_cvt_pk_bf16_f32 v31, v34, v35
    v_mfma_f32_16x16x32_bf16 v[52:55], v[212:215], v[80:83], v[52:55]
    buffer_store_dwordx4 v[28:31], v168, s[28:31], 0 offen offset:0 sc1
    v_cvt_pk_bf16_f32 v132, v44, v45
    v_cvt_pk_bf16_f32 v133, v46, v47
    v_mfma_f32_16x16x32_bf16 v[56:59], v[220:223], v[80:83], v[56:59]
    s_waitcnt lgkmcnt(3)
    v_cvt_pk_bf16_f32 v134, v48, v49
    v_cvt_pk_bf16_f32 v135, v50, v51
    v_add_f32_dpp v97, v97, v97 quad_perm:[2,3,0,1] row_mask:0xf bank_mask:0xf
    v_mfma_f32_16x16x32_bf16 v[152:155], v[84:87], v[140:143], 0
    v_cvt_pk_bf16_f32 v136, v52, v53
    v_cvt_pk_bf16_f32 v137, v54, v55
    v_add_f32_dpp v97, v97, v97 row_half_mirror row_mask:0xf bank_mask:0xf
    v_mfma_f32_16x16x32_bf16 v[148:151], v[76:79], v[132:135], 0
    ds_read2_b32 v[140:141], v171 offset0:32 offset1:32
    v_cvt_pk_bf16_f32 v138, v56, v57
    v_cvt_pk_bf16_f32 v139, v58, v59
    s_waitcnt lgkmcnt(2)
    v_mfma_f32_16x16x32_bf16 v[152:155], v[88:91], v[144:147], v[152:155]
    ds_read2_b32 v[142:143], v171 offset0:32 offset1:32
    v_rcp_f32 v97, v97
    v_mfma_f32_16x16x32_bf16 v[148:151], v[80:83], v[136:139], v[148:151]
    ds_read2_b32 v[144:145], v171 offset0:48 offset1:48
    v_mul_f32 v96, v96, v97
    v_cvt_pk_bf16_f32 v32, v36, v37
    v_cvt_pk_bf16_f32 v96, v96, v96
    v_mfma_f32_16x16x32_bf16 v[44:47], v[76:79], v[224:227], 0
    ds_write_b16 v187, v96
    v_cvt_pk_bf16_f32 v33, v38, v39
    v_cvt_pk_bf16_f32 v34, v40, v41
    v_cndmask_b32 v148, v152, v148, s[64:65]
    v_cndmask_b32 v149, v153, v149, s[64:65]
    v_cndmask_b32 v150, v154, v150, s[64:65]
    v_cndmask_b32 v151, v155, v151, s[64:65]
    v_max3_f32 v152, v148, v149, v150
    v_mfma_f32_16x16x32_bf16 v[48:51], v[76:79], v[232:235], 0
    ds_read_b64 v[92:93], v188 offset:0
    v_max_f32 v152, v152, v151
    v_cvt_pk_bf16_f32 v35, v42, v43
    v_mfma_f32_16x16x32_bf16 v[60:63], v[84:87], v[224:227], 0
    ds_read_b64 v[94:95], v189 offset:32
    v_mov_b32 v153, v152
    v_add_u32 v176, s69, v176
    v_mfma_f32_16x16x32_bf16 v[64:67], v[84:87], v[232:235], 0
    buffer_store_dwordx4 v[32:35], v168, s[28:31], 0 offen offset:64 sc1
    v_permlane16_swap_b32 v152, v153
    v_mfma_f32_16x16x32_bf16 v[52:55], v[76:79], v[240:243], 0
    ds_read2_b32 v[146:147], v171 offset0:48 offset1:48
    v_max_f32 v152, v152, v153
    v_add_u32 v177, s69, v177
    v_mfma_f32_16x16x32_bf16 v[56:59], v[76:79], v[248:251], 0
    v_sub_f32 v148, v148, v152
    v_sub_f32 v149, v149, v152
    v_sub_f32 v150, v150, v152
    v_mfma_f32_16x16x32_bf16 v[44:47], v[80:83], v[228:231], v[44:47]
    ds_read_b128 v[76:79], v176 offset:0
    v_sub_f32 v151, v151, v152
    v_exp_f32 v148, v148
    s_waitcnt lgkmcnt(2)
    v_mfma_f32_16x16x32_bf16 v[28:31], v[20:23], v[92:95], 0
    v_exp_f32 v149, v149
    v_exp_f32 v150, v150
    v_mfma_f32_16x16x32_bf16 v[32:35], v[24:27], v[92:95], 0
    ds_read_b64_tr_b16 v[22:23], v180 offset:6144
    v_exp_f32 v151, v151
    v_mfma_f32_16x16x32_bf16 v[36:39], v[156:159], v[92:95], 0
    ds_read_b64_tr_b16 v[26:27], v181 offset:6144
    v_add_f32 v152, v148, v149
    v_add_f32 v153, v150, v151
    v_mfma_f32_16x16x32_bf16 v[40:43], v[172:175], v[92:95], 0
    ds_read_b64_tr_b16 v[158:159], v182 offset:6144
    v_add_f32 v152, v152, v153
    v_cvt_pk_bf16_f32 v0, v44, v45
    v_mfma_f32_16x16x32_bf16 v[48:51], v[80:83], v[236:239], v[48:51]
    ds_read_b64 v[94:95], v186 offset:256
    v_mov_b32 v153, v152
    v_cvt_pk_bf16_f32 v1, v46, v47
    v_mfma_f32_16x16x32_bf16 v[68:71], v[84:87], v[240:243], 0
    ds_read_b64_tr_b16 v[174:175], v183 offset:6144
    v_permlane16_swap_b32 v152, v153
    v_mfma_f32_16x16x32_bf16 v[72:75], v[84:87], v[248:251], 0
    v_add_f32 v152, v152, v153
    v_cvt_pk_bf16_f32 v4, v48, v49
    v_rcp_f32 v152, v152
    v_mfma_f32_16x16x32_bf16 v[60:63], v[88:91], v[228:231], v[60:63]
    ds_read_b128 v[84:87], v176 offset:2048
    v_mul_f32 v148, v148, v152
    v_mul_f32 v149, v149, v152
    v_mfma_f32_16x16x32_bf16 v[64:67], v[88:91], v[236:239], v[64:67]
    v_mul_f32 v150, v150, v152
    v_mul_f32 v151, v151, v152
    v_cvt_pk_bf16_f32 v148, v148, v149
    v_mfma_f32_16x16x32_bf16 v[52:55], v[80:83], v[244:247], v[52:55]
    v_cvt_pk_bf16_f32 v149, v150, v151
    v_cvt_pk_bf16_f32 v5, v50, v51
    v_cvt_pk_bf16_f32 v20, v60, v61
    v_mfma_f32_16x16x32_bf16 v[56:59], v[80:83], v[252:255], v[56:59]
    v_cvt_pk_bf16_f32 v21, v62, v63
    v_cvt_pk_bf16_f32 v24, v64, v65
    v_cvt_pk_bf16_f32 v25, v66, v67
    v_mfma_f32_16x16x32_bf16 v[68:71], v[88:91], v[244:247], v[68:71]
    ds_read_b128 v[80:83], v177 offset:0
    v_cndmask_b32 v92, 0, v148, s[64:65]
    v_cndmask_b32 v93, 0, v149, s[64:65]
    v_mfma_f32_16x16x32_bf16 v[72:75], v[88:91], v[252:255], v[72:75]
    s_waitcnt lgkmcnt(3)
    v_cndmask_b32 v96, v148, 0, s[64:65]
    v_cndmask_b32 v97, v149, 0, s[64:65]
    v_cvt_pk_bf16_f32 v8, v52, v53
    v_mfma_f32_16x16x32_bf16 v[44:47], v[0:3], v[92:95], v[140:143]
    ds_read_b128 v[88:91], v177 offset:2048
    v_cvt_pk_bf16_f32 v9, v54, v55
    v_cvt_pk_bf16_f32 v16, v56, v57
    v_mfma_f32_16x16x32_bf16 v[48:51], v[4:7], v[92:95], v[140:143]
    v_cvt_pk_bf16_f32 v17, v58, v59
    v_cvt_pk_bf16_f32 v156, v68, v69
    v_cvt_pk_bf16_f32 v157, v70, v71
    v_mfma_f32_16x16x32_bf16 v[60:63], v[20:23], v[96:99], v[144:147]
    v_cvt_pk_bf16_f32 v172, v72, v73
    v_cvt_pk_bf16_f32 v173, v74, v75
    v_cvt_pk_bf16_f32 v132, v44, v45
    v_mfma_f32_16x16x32_bf16 v[64:67], v[24:27], v[96:99], v[144:147]
    v_cvt_pk_bf16_f32 v133, v46, v47
    v_cvt_pk_bf16_f32 v134, v48, v49
    v_cvt_pk_bf16_f32 v135, v50, v51
    v_mfma_f32_16x16x32_bf16 v[52:55], v[8:11], v[92:95], v[140:143]
    ds_write_b128 v184, v[132:135] offset:4096
    v_mfma_f32_16x16x32_bf16 v[56:59], v[16:19], v[92:95], v[140:143]
    v_mov_b32 v168, v12
    v_mov_b32 v12, v13
    v_mov_b32 v13, v14
    v_mfma_f32_16x16x32_bf16 v[68:71], v[156:159], v[96:99], v[144:147]
    s_waitcnt lgkmcnt(4)
    v_cvt_pk_bf16_f32 v140, v60, v61
    v_cvt_pk_bf16_f32 v141, v62, v63
    v_cvt_pk_bf16_f32 v142, v64, v65
    v_mfma_f32_16x16x32_bf16 v[72:75], v[172:175], v[96:99], v[144:147]
    v_cvt_pk_bf16_f32 v143, v66, v67
    v_cvt_pk_bf16_f32 v136, v52, v53
    v_cvt_pk_bf16_f32 v137, v54, v55
    v_mfma_f32_16x16x32_bf16 v[92:95], v[132:135], v[132:135], 0
    ds_write_b128 v184, v[140:143] offset:6144
    v_mfma_f32_16x16x32_bf16 v[96:99], v[140:143], v[140:143], 0
    v_cvt_pk_bf16_f32 v138, v56, v57
    v_cvt_pk_bf16_f32 v139, v58, v59
    v_cvt_pk_bf16_f32 v144, v68, v69
    v_mfma_f32_16x16x32_bf16 v[148:151], v[160:163], v[132:135], 0
    ds_write_b128 v185, v[136:139] offset:4096
    v_mfma_f32_16x16x32_bf16 v[152:155], v[160:163], v[140:143], 0
    ds_read_b64_tr_b16 v[20:21], v180 offset:4096
    v_cvt_pk_bf16_f32 v145, v70, v71
    v_cvt_pk_bf16_f32 v146, v72, v73
    v_mfma_f32_16x16x32_bf16 v[92:95], v[136:139], v[136:139], v[92:95]
    ds_read_b64_tr_b16 v[24:25], v181 offset:4096
    v_cvt_pk_bf16_f32 v147, v74, v75
    v_mov_b32 v14, v15
    v_mfma_f32_16x16x32_bf16 v[148:151], v[164:167], v[136:139], v[148:151]
    ds_write_b128 v185, v[144:147] offset:6144
    v_mfma_f32_16x16x32_bf16 v[96:99], v[144:147], v[144:147], v[96:99]
    ds_read_b64_tr_b16 v[156:157], v182 offset:4096
    v_add_u32 v178, s69, v178
    v_add_u32 v179, s69, v179
    v_mfma_f32_16x16x32_bf16 v[152:155], v[164:167], v[144:147], v[152:155]
    ds_read_b64_tr_b16 v[172:173], v183 offset:4096
    v_add_u32 v184, s69, v184
    v_add_u32 v185, s69, v185
    v_add_u32 v186, 512, v186
    v_add_u32 v171, 256, v171
    ds_read_b64_tr_b16 v[22:23], v180 offset:6144
    v_add_u32 v180, s69, v180
    ds_read_b64_tr_b16 v[26:27], v181 offset:6144
    v_add_u32 v181, s69, v181
    ds_read_b64_tr_b16 v[158:159], v182 offset:6144
    v_add_u32 v182, s69, v182
    ds_read_b64_tr_b16 v[174:175], v183 offset:6144
    v_add_u32 v183, s69, v183
    s_add_u32 s68, s68, 1
    s_cmp_lg_u32 s68, 1
    s_cbranch_scc1 F_NODUMP
    s_cmp_eq_u32 s3, 7
    s_cbranch_scc1 F_P_1
    s_setprio 1
F_P_1:
    ds_write_b128 v169, v[100:103]
    v_xor_b32 v169, 144, v169
    ds_write_b128 v169, v[104:107]
    v_xor_b32 v169, 432, v169
    ds_write_b128 v169, v[108:111]
    v_xor_b32 v169, 144, v169
    ds_write_b128 v169, v[112:115]
    v_xor_b32 v169, 1008, v169
    ds_write_b128 v169, v[116:119]
    v_xor_b32 v169, 144, v169
    ds_write_b128 v169, v[120:123]
    v_xor_b32 v169, 432, v169
    ds_write_b128 v169, v[124:127]
    v_xor_b32 v169, 144, v169
    ds_write_b128 v169, v[128:131]
    s_mov_b32 s69, -8192
    s_branch F_LOOP
F_NODUMP:
    s_mov_b32 s69, 16384
    s_cmp_eq_u32 s68, 3
    s_cbranch_scc1 F_TAIL
    s_setprio 1
    s_cmp_eq_u32 s3, 7
    s_cbranch_scc1 F_P_2
    s_setprio 0
F_P_2:
    s_branch F_LOOP
F_TAIL:
    s_cmp_eq_u32 s3, 7
    s_cbranch_scc1 F_EXTRA
    v_cndmask_b32 v92, v92, v93, s[70:71]
    v_cndmask_b32 v94, v94, v95, s[70:71]
    v_cndmask_b32 v96, v96, v97, s[70:71]
    v_cndmask_b32 v98, v98, v99, s[70:71]
    v_cndmask_b32 v92, v92, v94, s[72:73]
    v_cndmask_b32 v96, v96, v98, s[72:73]
    v_cndmask_b32 v152, v148, v152, s[78:79]
    v_cndmask_b32 v153, v149, v153, s[78:79]
    v_permlane32_swap_b32 v92, v96
    v_fma_f32 v99, v152, s66, v153
    v_cndmask_b32 v96, v92, v96, s[76:77]
    v_mov_b32 v97, v96
    s_nop 1
    v_permlane16_swap_b32 v96, v97
    v_cndmask_b32 v96, v96, v97, s[74:75]
    v_fma_f32 v96, -v152, v152, v96
    v_fma_f32 v96, |v96|, s67, v170
    v_rsq_f32 v96, v96
    s_nop 0
    v_mul_f32 v96, v96, v99
    s_nop 1
    v_max_f32_dpp v97, v96, v96 quad_perm:[1,0,3,2] row_mask:0xf bank_mask:0xf
    s_nop 1
    v_max_f32_dpp v97, v97, v97 quad_perm:[2,3,0,1] row_mask:0xf bank_mask:0xf
    s_nop 1
    v_max_f32_dpp v97, v97, v97 row_half_mirror row_mask:0xf bank_mask:0xf
    v_sub_f32 v96, v96, v97
    v_exp_f32 v96, v96
    s_nop 1
    v_add_f32_dpp v97, v96, v96 quad_perm:[1,0,3,2] row_mask:0xf bank_mask:0xf
    s_nop 1
    v_add_f32_dpp v97, v97, v97 quad_perm:[2,3,0,1] row_mask:0xf bank_mask:0xf
    s_nop 1
    v_add_f32_dpp v97, v97, v97 row_half_mirror row_mask:0xf bank_mask:0xf
    v_rcp_f32 v97, v97
    s_nop 0
    v_mul_f32 v96, v96, v97
    v_cvt_pk_bf16_f32 v96, v96, v96
    ds_write_b16 v187, v96
    ds_read_b64 v[92:93], v190 offset:0
    ds_read_b64 v[94:95], v191 offset:32
    s_waitcnt lgkmcnt(0)
    v_mfma_f32_16x16x32_bf16 v[28:31], v[20:23], v[92:95], v[28:31]
    v_mfma_f32_16x16x32_bf16 v[32:35], v[24:27], v[92:95], v[32:35]
    v_mfma_f32_16x16x32_bf16 v[36:39], v[156:159], v[92:95], v[36:39]
    v_mfma_f32_16x16x32_bf16 v[40:43], v[172:175], v[92:95], v[40:43]
    s_nop 4
    v_cvt_pk_bf16_f32 v28, v28, v29
    v_cvt_pk_bf16_f32 v29, v30, v31
    v_cvt_pk_bf16_f32 v30, v32, v33
    v_cvt_pk_bf16_f32 v31, v34, v35
    buffer_store_dwordx4 v[28:31], v168, s[28:31], 0 offen offset:0 sc1
    v_cvt_pk_bf16_f32 v32, v36, v37
    v_cvt_pk_bf16_f32 v33, v38, v39
    v_cvt_pk_bf16_f32 v34, v40, v41
    v_cvt_pk_bf16_f32 v35, v42, v43
    buffer_store_dwordx4 v[32:35], v168, s[28:31], 0 offen offset:64 sc1
    s_branch K2_END
F_EXTRA:
    s_waitcnt lgkmcnt(14)
    v_mfma_f32_16x16x32_bf16 v[60:63], v[192:195], v[84:87], 0
    ds_read_b64_tr_b16 v[2:3], v180 offset:0
    ds_read_b64_tr_b16 v[6:7], v181 offset:0
    v_mfma_f32_16x16x32_bf16 v[64:67], v[200:203], v[84:87], 0
    ds_read_b64_tr_b16 v[10:11], v182 offset:0
    ds_read_b64_tr_b16 v[18:19], v183 offset:0
    v_mfma_f32_16x16x32_bf16 v[68:71], v[208:211], v[84:87], 0
    v_cndmask_b32 v92, v92, v93, s[70:71]
    v_cndmask_b32 v94, v94, v95, s[70:71]
    v_cndmask_b32 v96, v96, v97, s[70:71]
    v_mfma_f32_16x16x32_bf16 v[72:75], v[216:219], v[84:87], 0
    s_waitcnt lgkmcnt(14)
    v_cndmask_b32 v98, v98, v99, s[70:71]
    v_cndmask_b32 v92, v92, v94, s[72:73]
    v_cndmask_b32 v96, v96, v98, s[72:73]
    v_mfma_f32_16x16x32_bf16 v[60:63], v[196:199], v[88:91], v[60:63]
    ds_read_b128 v[84:87], v178 offset:2048
    v_permlane32_swap_b32 v92, v96
    v_mfma_f32_16x16x32_bf16 v[64:67], v[204:207], v[88:91], v[64:67]
    v_cndmask_b32 v96, v92, v96, s[76:77]
    v_cndmask_b32 v152, v148, v152, s[78:79]
    v_mov_b32 v97, v96
    v_mfma_f32_16x16x32_bf16 v[68:71], v[212:215], v[88:91], v[68:71]
    s_nop 0
    v_permlane16_swap_b32 v96, v97
    v_cndmask_b32 v153, v149, v153, s[78:79]
    v_mfma_f32_16x16x32_bf16 v[72:75], v[220:223], v[88:91], v[72:75]
    v_cndmask_b32 v96, v96, v97, s[74:75]
    v_fma_f32 v99, v152, s66, v153
    v_fma_f32 v96, -v152, v152, v96
    v_mfma_f32_16x16x32_bf16 v[44:47], v[192:195], v[76:79], 0
    ds_read_b128 v[88:91], v179 offset:2048
    v_fma_f32 v96, |v96|, s67, v170
    v_cvt_pk_bf16_f32 v140, v60, v61
    v_mfma_f32_16x16x32_bf16 v[48:51], v[200:203], v[76:79], 0
    v_rsq_f32 v96, v96
    v_cvt_pk_bf16_f32 v141, v62, v63
    v_mfma_f32_16x16x32_bf16 v[52:55], v[208:211], v[76:79], 0
    v_mul_f32 v96, v96, v99
    v_cvt_pk_bf16_f32 v142, v64, v65
    v_cvt_pk_bf16_f32 v143, v66, v67
    v_mfma_f32_16x16x32_bf16 v[56:59], v[216:219], v[76:79], 0
    ds_read_b64 v[98:99], v186 offset:128
    v_max_f32_dpp v97, v96, v96 quad_perm:[1,0,3,2] row_mask:0xf bank_mask:0xf
    v_cvt_pk_bf16_f32 v144, v68, v69
    v_mfma_f32_16x16x32_bf16 v[44:47], v[196:199], v[80:83], v[44:47]
    v_max_f32_dpp v97, v97, v97 quad_perm:[2,3,0,1] row_mask:0xf bank_mask:0xf
    v_cvt_pk_bf16_f32 v145, v70, v71
    v_cvt_pk_bf16_f32 v146, v72, v73
    v_mfma_f32_16x16x32_bf16 v[48:51], v[204:207], v[80:83], v[48:51]
    v_max_f32_dpp v97, v97, v97 row_half_mirror row_mask:0xf bank_mask:0xf
    v_cvt_pk_bf16_f32 v147, v74, v75
    v_sub_f32 v96, v96, v97
    v_mfma_f32_16x16x32_bf16 v[52:55], v[212:215], v[80:83], v[52:55]
    v_exp_f32 v96, v96
    v_cvt_pk_bf16_f32 v132, v44, v45
    v_mfma_f32_16x16x32_bf16 v[56:59], v[220:223], v[80:83], v[56:59]
    s_waitcnt lgkmcnt(2)
    v_add_f32_dpp v97, v96, v96 quad_perm:[1,0,3,2] row_mask:0xf bank_mask:0xf
    v_cvt_pk_bf16_f32 v133, v46, v47
    v_cvt_pk_bf16_f32 v134, v48, v49
    v_mfma_f32_16x16x32_bf16 v[152:155], v[84:87], v[140:143], 0
    v_cvt_pk_bf16_f32 v135, v50, v51
    v_add_f32_dpp v97, v97, v97 quad_perm:[2,3,0,1] row_mask:0xf bank_mask:0xf
    v_cvt_pk_bf16_f32 v136, v52, v53
    v_mfma_f32_16x16x32_bf16 v[148:151], v[76:79], v[132:135], 0
    ds_read2_b32 v[140:141], v171 offset0:0 offset1:0
    v_cvt_pk_bf16_f32 v137, v54, v55
    v_cvt_pk_bf16_f32 v138, v56, v57
    s_waitcnt lgkmcnt(2)
    v_mfma_f32_16x16x32_bf16 v[152:155], v[88:91], v[144:147], v[152:155]
    ds_read2_b32 v[142:143], v171 offset0:0 offset1:0
    v_cvt_pk_bf16_f32 v139, v58, v59
    v_add_f32_dpp v97, v97, v97 row_half_mirror row_mask:0xf bank_mask:0xf
    v_mfma_f32_16x16x32_bf16 v[44:47], v[76:79], v[224:227], 0
    ds_read2_b32 v[144:145], v171 offset0:16 offset1:16
    v_rcp_f32 v97, v97
    v_mfma_f32_16x16x32_bf16 v[148:151], v[80:83], v[136:139], v[148:151]
    ds_read2_b32 v[146:147], v171 offset0:16 offset1:16
    v_mul_f32 v96, v96, v97
    v_cvt_pk_bf16_f32 v96, v96, v96
    v_mfma_f32_16x16x32_bf16 v[48:51], v[76:79], v[232:235], 0
    ds_write_b16 v187, v96
    ds_read_b64 v[92:93], v190 offset:0
    v_mfma_f32_16x16x32_bf16 v[60:63], v[84:87], v[224:227], 0
    ds_read_b64 v[94:95], v191 offset:32
    v_cndmask_b32 v148, v152, v148, s[64:65]
    v_cndmask_b32 v149, v153, v149, s[64:65]
    v_cndmask_b32 v150, v154, v150, s[64:65]
    v_cndmask_b32 v151, v155, v151, s[64:65]
    v_max3_f32 v152, v148, v149, v150
    v_mfma_f32_16x16x32_bf16 v[64:67], v[84:87], v[232:235], 0
    v_max_f32 v152, v152, v151
    v_mov_b32 v153, v152
    v_mfma_f32_16x16x32_bf16 v[52:55], v[76:79], v[240:243], 0
    s_nop 0
    v_permlane16_swap_b32 v152, v153
    v_mfma_f32_16x16x32_bf16 v[68:71], v[84:87], v[240:243], 0
    v_max_f32 v152, v152, v153
    v_sub_f32 v148, v148, v152
    v_mfma_f32_16x16x32_bf16 v[56:59], v[76:79], v[248:251], 0
    s_waitcnt lgkmcnt(0)
    v_sub_f32 v149, v149, v152
    v_sub_f32 v150, v150, v152
    v_sub_f32 v151, v151, v152
    v_mfma_f32_16x16x32_bf16 v[28:31], v[20:23], v[92:95], v[28:31]
    v_exp_f32 v148, v148
    v_exp_f32 v149, v149
    v_mfma_f32_16x16x32_bf16 v[32:35], v[24:27], v[92:95], v[32:35]
    ds_read_b64_tr_b16 v[22:23], v180 offset:2048
    v_exp_f32 v150, v150
    v_mfma_f32_16x16x32_bf16 v[36:39], v[156:159], v[92:95], v[36:39]
    ds_read_b64_tr_b16 v[26:27], v181 offset:2048
    v_exp_f32 v151, v151
    v_mfma_f32_16x16x32_bf16 v[40:43], v[172:175], v[92:95], v[40:43]
    ds_read_b64_tr_b16 v[158:159], v182 offset:2048
    v_add_f32 v152, v148, v149
    v_add_f32 v153, v150, v151
    v_mfma_f32_16x16x32_bf16 v[44:47], v[80:83], v[228:231], v[44:47]
    ds_read_b64 v[94:95], v186 offset:0
    v_add_f32 v152, v152, v153
    ds_read_b64_tr_b16 v[174:175], v183 offset:2048
    v_mfma_f32_16x16x32_bf16 v[48:51], v[80:83], v[236:239], v[48:51]
    v_mov_b32 v153, v152
    v_cvt_pk_bf16_f32 v28, v28, v29
    v_cvt_pk_bf16_f32 v29, v30, v31
    v_mfma_f32_16x16x32_bf16 v[72:75], v[84:87], v[248:251], 0
    v_permlane16_swap_b32 v152, v153
    v_cvt_pk_bf16_f32 v0, v44, v45
    v_mfma_f32_16x16x32_bf16 v[60:63], v[88:91], v[228:231], v[60:63]
    v_add_f32 v152, v152, v153
    v_cvt_pk_bf16_f32 v1, v46, v47
    v_rcp_f32 v152, v152
    v_mfma_f32_16x16x32_bf16 v[64:67], v[88:91], v[236:239], v[64:67]
    v_mul_f32 v148, v148, v152
    v_mul_f32 v149, v149, v152
    v_mul_f32 v150, v150, v152
    v_mfma_f32_16x16x32_bf16 v[52:55], v[80:83], v[244:247], v[52:55]
    v_mul_f32 v151, v151, v152
    v_cvt_pk_bf16_f32 v148, v148, v149
    v_cvt_pk_bf16_f32 v149, v150, v151
    v_mfma_f32_16x16x32_bf16 v[56:59], v[80:83], v[252:255], v[56:59]
    v_cvt_pk_bf16_f32 v4, v48, v49
    v_cvt_pk_bf16_f32 v5, v50, v51
    v_cvt_pk_bf16_f32 v20, v60, v61
    v_mfma_f32_16x16x32_bf16 v[68:71], v[88:91], v[244:247], v[68:71]
    v_cvt_pk_bf16_f32 v21, v62, v63
    v_cvt_pk_bf16_f32 v24, v64, v65
    v_cvt_pk_bf16_f32 v25, v66, v67
    v_mfma_f32_16x16x32_bf16 v[72:75], v[88:91], v[252:255], v[72:75]
    s_waitcnt lgkmcnt(1)
    v_cndmask_b32 v92, 0, v148, s[64:65]
    v_cndmask_b32 v93, 0, v149, s[64:65]
    v_cndmask_b32 v96, v148, 0, s[64:65]
    v_cndmask_b32 v97, v149, 0, s[64:65]
    v_mfma_f32_16x16x32_bf16 v[44:47], v[0:3], v[92:95], v[140:143]
    v_cvt_pk_bf16_f32 v8, v52, v53
    v_cvt_pk_bf16_f32 v9, v54, v55
    v_cvt_pk_bf16_f32 v16, v56, v57
    v_mfma_f32_16x16x32_bf16 v[48:51], v[4:7], v[92:95], v[140:143]
    v_cvt_pk_bf16_f32 v17, v58, v59
    v_cvt_pk_bf16_f32 v156, v68, v69
    v_cvt_pk_bf16_f32 v157, v70, v71
    v_mfma_f32_16x16x32_bf16 v[60:63], v[20:23], v[96:99], v[144:147]
    v_cvt_pk_bf16_f32 v172, v72, v73
    v_cvt_pk_bf16_f32 v173, v74, v75
    v_cvt_pk_bf16_f32 v132, v44, v45
    v_mfma_f32_16x16x32_bf16 v[64:67], v[24:27], v[96:99], v[144:147]
    v_cvt_pk_bf16_f32 v133, v46, v47
    v_cvt_pk_bf16_f32 v134, v48, v49
    v_cvt_pk_bf16_f32 v135, v50, v51
    v_mfma_f32_16x16x32_bf16 v[52:55], v[8:11], v[92:95], v[140:143]
    ds_write_b128 v184, v[132:135] offset:0
    v_mfma_f32_16x16x32_bf16 v[56:59], v[16:19], v[92:95], v[140:143]
    v_cvt_pk_bf16_f32 v30, v32, v33
    v_cvt_pk_bf16_f32 v31, v34, v35
    v_cvt_pk_bf16_f32 v32, v36, v37
    v_mfma_f32_16x16x32_bf16 v[68:71], v[156:159], v[96:99], v[144:147]
    buffer_store_dwordx4 v[28:31], v168, s[28:31], 0 offen offset:0 sc1
    v_cvt_pk_bf16_f32 v140, v60, v61
    v_cvt_pk_bf16_f32 v141, v62, v63
    s_waitcnt lgkmcnt(1)
    v_mfma_f32_16x16x32_bf16 v[72:75], v[172:175], v[96:99], v[144:147]
    v_cvt_pk_bf16_f32 v142, v64, v65
    v_cvt_pk_bf16_f32 v143, v66, v67
    v_cvt_pk_bf16_f32 v136, v52, v53
    v_mfma_f32_16x16x32_bf16 v[92:95], v[132:135], v[132:135], 0
    ds_write_b128 v184, v[140:143] offset:2048
    v_mfma_f32_16x16x32_bf16 v[96:99], v[140:143], v[140:143], 0
    v_cvt_pk_bf16_f32 v137, v54, v55
    v_cvt_pk_bf16_f32 v138, v56, v57
    v_cvt_pk_bf16_f32 v139, v58, v59
    v_mfma_f32_16x16x32_bf16 v[148:151], v[160:163], v[132:135], 0
    ds_write_b128 v185, v[136:139] offset:0
    v_mfma_f32_16x16x32_bf16 v[92:95], v[136:139], v[136:139], v[92:95]
    ds_read_b64_tr_b16 v[20:21], v180 offset:0
    v_cvt_pk_bf16_f32 v144, v68, v69
    v_cvt_pk_bf16_f32 v145, v70, v71
    v_mfma_f32_16x16x32_bf16 v[152:155], v[160:163], v[140:143], 0
    ds_read_b64_tr_b16 v[24:25], v181 offset:0
    v_cvt_pk_bf16_f32 v146, v72, v73
    v_cvt_pk_bf16_f32 v147, v74, v75
    v_mfma_f32_16x16x32_bf16 v[148:151], v[164:167], v[136:139], v[148:151]
    ds_write_b128 v185, v[144:147] offset:2048
    v_mfma_f32_16x16x32_bf16 v[96:99], v[144:147], v[144:147], v[96:99]
    ds_read_b64_tr_b16 v[22:23], v180 offset:2048
    v_cndmask_b32 v92, v92, v93, s[70:71]
    v_cndmask_b32 v94, v94, v95, s[70:71]
    v_mfma_f32_16x16x32_bf16 v[152:155], v[164:167], v[144:147], v[152:155]
    ds_read_b64_tr_b16 v[26:27], v181 offset:2048
    v_cndmask_b32 v92, v92, v94, s[72:73]
    v_cvt_pk_bf16_f32 v33, v38, v39
    v_cvt_pk_bf16_f32 v34, v40, v41
    v_cndmask_b32 v96, v96, v97, s[70:71]
    v_cndmask_b32 v98, v98, v99, s[70:71]
    v_cvt_pk_bf16_f32 v35, v42, v43
    v_cndmask_b32 v96, v96, v98, s[72:73]
    ds_read_b64_tr_b16 v[156:157], v182 offset:0
    v_cndmask_b32 v152, v148, v152, s[78:79]
    v_permlane32_swap_b32 v92, v96
    v_cndmask_b32 v153, v149, v153, s[78:79]
    ds_read_b64_tr_b16 v[172:173], v183 offset:0
    v_cndmask_b32 v96, v92, v96, s[76:77]
    v_fma_f32 v99, v152, s66, v153
    v_mov_b32 v97, v96
    ds_read_b64_tr_b16 v[158:159], v182 offset:2048
    ds_read_b64_tr_b16 v[174:175], v183 offset:2048
    v_permlane16_swap_b32 v96, v97
    buffer_store_dwordx4 v[32:35], v168, s[28:31], 0 offen offset:64 sc1
    v_cndmask_b32 v96, v96, v97, s[74:75]
    v_fma_f32 v96, -v152, v152, v96
    v_mov_b32 v168, v12
    v_fma_f32 v96, |v96|, s67, v170
    v_rsq_f32 v96, v96
    s_nop 0
    v_mul_f32 v96, v96, v99
    s_nop 1
    v_max_f32_dpp v97, v96, v96 quad_perm:[1,0,3,2] row_mask:0xf bank_mask:0xf
    s_nop 1
    v_max_f32_dpp v97, v97, v97 quad_perm:[2,3,0,1] row_mask:0xf bank_mask:0xf
    s_nop 1
    v_max_f32_dpp v97, v97, v97 row_half_mirror row_mask:0xf bank_mask:0xf
    v_sub_f32 v96, v96, v97
    v_exp_f32 v96, v96
    s_nop 1
    v_add_f32_dpp v97, v96, v96 quad_perm:[1,0,3,2] row_mask:0xf bank_mask:0xf
    s_nop 1
    v_add_f32_dpp v97, v97, v97 quad_perm:[2,3,0,1] row_mask:0xf bank_mask:0xf
    s_nop 1
    v_add_f32_dpp v97, v97, v97 row_half_mirror row_mask:0xf bank_mask:0xf
    v_rcp_f32 v97, v97
    s_nop 0
    v_mul_f32 v96, v96, v97
    v_cvt_pk_bf16_f32 v96, v96, v96
    ds_write_b16 v187, v96
    ds_read_b64 v[92:93], v188 offset:0
    ds_read_b64 v[94:95], v189 offset:32
    s_waitcnt lgkmcnt(0)
    v_mfma_f32_16x16x32_bf16 v[28:31], v[20:23], v[92:95], 0
    v_mfma_f32_16x16x32_bf16 v[32:35], v[24:27], v[92:95], 0
    v_mfma_f32_16x16x32_bf16 v[36:39], v[156:159], v[92:95], 0
    v_mfma_f32_16x16x32_bf16 v[40:43], v[172:175], v[92:95], 0
    s_nop 4
    v_cvt_pk_bf16_f32 v28, v28, v29
    v_cvt_pk_bf16_f32 v29, v30, v31
    v_cvt_pk_bf16_f32 v30, v32, v33
    v_cvt_pk_bf16_f32 v31, v34, v35
    buffer_store_dwordx4 v[28:31], v168, s[28:31], 0 offen offset:0 sc1
    v_cvt_pk_bf16_f32 v32, v36, v37
    v_cvt_pk_bf16_f32 v33, v38, v39
    v_cvt_pk_bf16_f32 v34, v40, v41
    v_cvt_pk_bf16_f32 v35, v42, v43
    buffer_store_dwordx4 v[32:35], v168, s[28:31], 0 offen offset:64 sc1
K2_END:
K2_EXIT:
    s_endpgm
S_WEIGHTS:
    s_load_dwordx8 s[64:71], s[0:1], 32
    s_load_dwordx2 s[72:73], s[0:1], 64
    v_and_b32 v179, 15, v1
    v_lshrrev_b32 v180, 4, v1
    s_add_u32 s74, s14, 104136704
    s_addc_u32 s75, s15, 0
    s_cmp_eq_u32 s6, 2
    s_cbranch_scc1 S_MD
    v_lshrrev_b32 v181, 2, v179
    v_and_b32 v182, 3, v179
    v_lshl_add_u32 v181, v181, 3, v182
    v_lshlrev_b32 v181, 7, v181
    v_lshl_add_u32 v181, v180, 4, v181
    v_add_u32 v182, 4096, v181
    s_and_b32 s54, s3, 3
    s_cmp_ge_u32 s3, 4
    s_waitcnt lgkmcnt(0)
    s_cbranch_scc1 S_WV
    global_load_dwordx4 v[192:195], v181, s[64:65] offset:0
    global_load_dwordx4 v[196:199], v181, s[64:65] offset:64
    global_load_dwordx4 v[200:203], v181, s[64:65] offset:512
    global_load_dwordx4 v[204:207], v181, s[64:65] offset:576
    global_load_dwordx4 v[208:211], v182, s[64:65] offset:0
    global_load_dwordx4 v[212:215], v182, s[64:65] offset:64
    global_load_dwordx4 v[216:219], v182, s[64:65] offset:512
    global_load_dwordx4 v[220:223], v182, s[64:65] offset:576
    s_lshr_b32 s55, s54, 1
    s_lshl_b32 s55, s55, 12
    s_and_b32 s56, s54, 1
    s_lshl_b32 s56, s56, 9
    s_add_u32 s55, s55, s56
    v_add_u32 v183, s55, v181
    global_load_dwordx4 v[184:187], v183, s[66:67]
    global_load_dwordx4 v[188:191], v183, s[66:67] offset:64
    s_mov_b32 s57, 0x3e38aa3b
    s_branch S_WMM
S_WV:
    global_load_dwordx4 v[192:195], v181, s[68:69] offset:0
    global_load_dwordx4 v[196:199], v181, s[68:69] offset:64
    global_load_dwordx4 v[200:203], v181, s[68:69] offset:512
    global_load_dwordx4 v[204:207], v181, s[68:69] offset:576
    global_load_dwordx4 v[208:211], v182, s[68:69] offset:0
    global_load_dwordx4 v[212:215], v182, s[68:69] offset:64
    global_load_dwordx4 v[216:219], v182, s[68:69] offset:512
    global_load_dwordx4 v[220:223], v182, s[68:69] offset:576
    s_lshl_b32 s55, s54, 5
    v_lshlrev_b32 v183, 10, v180
    v_lshl_add_u32 v183, v179, 1, v183
    v_add_u32 v183, s55, v183
    v_add_u32 v224, 4096, v183
    global_load_ushort v240, v183, s[70:71] offset:0
    global_load_ushort v241, v183, s[70:71] offset:128
    global_load_ushort v242, v183, s[70:71] offset:256
    global_load_ushort v243, v183, s[70:71] offset:384
    global_load_ushort v244, v183, s[70:71] offset:512
    global_load_ushort v245, v183, s[70:71] offset:640
    global_load_ushort v246, v183, s[70:71] offset:768
    global_load_ushort v247, v183, s[70:71] offset:896
    global_load_ushort v248, v224, s[70:71] offset:0
    global_load_ushort v249, v224, s[70:71] offset:128
    global_load_ushort v250, v224, s[70:71] offset:256
    global_load_ushort v251, v224, s[70:71] offset:384
    global_load_ushort v252, v224, s[70:71] offset:512
    global_load_ushort v253, v224, s[70:71] offset:640
    global_load_ushort v254, v224, s[70:71] offset:768
    global_load_ushort v255, v224, s[70:71] offset:896
    s_waitcnt vmcnt(0)
    v_lshl_or_b32 v184, v241, 16, v240
    v_lshl_or_b32 v185, v243, 16, v242
    v_lshl_or_b32 v186, v245, 16, v244
    v_lshl_or_b32 v187, v247, 16, v246
    v_lshl_or_b32 v188, v249, 16, v248
    v_lshl_or_b32 v189, v251, 16, v250
    v_lshl_or_b32 v190, v253, 16, v252
    v_lshl_or_b32 v191, v255, 16, v254
    s_mov_b32 s57, 1.0
S_WMM:
    s_lshl_b32 s55, s3, 11
    v_lshl_add_u32 v183, v1, 4, s55
    s_waitcnt vmcnt(0)
    v_mfma_f32_16x16x32_bf16 v[224:227], v[192:195], v[184:187], 0
    v_mfma_f32_16x16x32_bf16 v[228:231], v[200:203], v[184:187], 0
    v_mfma_f32_16x16x32_bf16 v[232:235], v[208:211], v[184:187], 0
    v_mfma_f32_16x16x32_bf16 v[236:239], v[216:219], v[184:187], 0
    v_mfma_f32_16x16x32_bf16 v[224:227], v[196:199], v[188:191], v[224:227]
    v_mfma_f32_16x16x32_bf16 v[228:231], v[204:207], v[188:191], v[228:231]
    v_mfma_f32_16x16x32_bf16 v[232:235], v[212:215], v[188:191], v[232:235]
    v_mfma_f32_16x16x32_bf16 v[236:239], v[220:223], v[188:191], v[236:239]
    s_nop 7
    v_mul_f32 v224, s57, v224
    v_mul_f32 v225, s57, v225
    v_mul_f32 v226, s57, v226
    v_mul_f32 v227, s57, v227
    v_mul_f32 v228, s57, v228
    v_mul_f32 v229, s57, v229
    v_mul_f32 v230, s57, v230
    v_mul_f32 v231, s57, v231
    v_mul_f32 v232, s57, v232
    v_mul_f32 v233, s57, v233
    v_mul_f32 v234, s57, v234
    v_mul_f32 v235, s57, v235
    v_mul_f32 v236, s57, v236
    v_mul_f32 v237, s57, v237
    v_mul_f32 v238, s57, v238
    v_mul_f32 v239, s57, v239
    v_cvt_pk_bf16_f32 v192, v224, v225
    v_cvt_pk_bf16_f32 v193, v226, v227
    v_cvt_pk_bf16_f32 v194, v228, v229
    v_cvt_pk_bf16_f32 v195, v230, v231
    v_cvt_pk_bf16_f32 v196, v232, v233
    v_cvt_pk_bf16_f32 v197, v234, v235
    v_cvt_pk_bf16_f32 v198, v236, v237
    v_cvt_pk_bf16_f32 v199, v238, v239
    global_store_dwordx4 v183, v[192:195], s[74:75] sc1
    global_store_dwordx4 v183, v[196:199], s[74:75] offset:1024 sc1
    s_branch K2_WDONE
S_MD:
    s_cmp_lg_u32 s3, 1
    s_waitcnt lgkmcnt(0)
    s_cbranch_scc1 K2_WDONE
    v_lshlrev_b32 v181, 3, v180
    v_lshlrev_b32 v182, 1, v1
    v_mov_b32 v183, 0
    global_load_dwordx2 v[184:185], v181, s[72:73] offset:0
    global_load_dwordx2 v[186:187], v181, s[72:73] offset:32
    global_load_dwordx2 v[188:189], v181, s[72:73] offset:64
    global_load_dwordx2 v[190:191], v181, s[72:73] offset:96
    global_load_short_d16_hi v183, v182, s[72:73]
    v_and_b32 v181, 3, v179
    v_cmp_eq_u32 s[54:55], 0, v181
    v_cmp_eq_u32 s[56:57], 1, v181
    v_mov_b32 v182, 0x3e003e00
    s_nop 0
    v_cndmask_b32 v224, 0, v182, s[54:55]
    s_waitcnt vmcnt(0)
    v_cndmask_b32 v192, v224, v184, s[56:57]
    v_cndmask_b32 v193, v224, v185, s[56:57]
    v_cndmask_b32 v194, v224, v186, s[56:57]
    v_cndmask_b32 v195, v224, v187, s[56:57]
    v_cndmask_b32 v196, v224, v188, s[56:57]
    v_cndmask_b32 v197, v224, v189, s[56:57]
    v_cndmask_b32 v198, v224, v190, s[56:57]
    v_cndmask_b32 v199, v224, v191, s[56:57]
    v_lshlrev_b32 v181, 4, v1
    v_add_u32 v181, 16384, v181
    global_store_dwordx4 v181, v[192:195], s[74:75] offset:0 sc1
    global_store_dwordx4 v181, v[196:199], s[74:75] offset:1024 sc1
    s_nop 1
    v_add_f32_dpp v183, v183, v183 row_shr:1 row_mask:0xf bank_mask:0xf
    s_nop 1
    v_add_f32_dpp v183, v183, v183 row_shr:2 row_mask:0xf bank_mask:0xf
    s_nop 1
    v_add_f32_dpp v183, v183, v183 row_shr:4 row_mask:0xf bank_mask:0xf
    s_nop 1
    v_add_f32_dpp v183, v183, v183 row_shr:8 row_mask:0xf bank_mask:0xf
    s_nop 1
    v_add_f32_dpp v183, v183, v183 row_bcast:15 row_mask:0xa bank_mask:0xf
    s_nop 1
    v_add_f32_dpp v183, v183, v183 row_bcast:31 row_mask:0xc bank_mask:0xf
    v_lshlrev_b32 v181, 2, v1
    v_mul_f32 v183, 0xbe000000, v183
    v_add_u32 v181, 20480, v181
    global_store_dword v181, v183, s[74:75] sc1
    s_branch K2_WDONE
K2_CODE_END:
.section .rodata,"a"
.p2align 6
.amdhsa_kernel standalone__hybrid_graph_tf_nagphormer__graph_kernel
  .amdhsa_next_free_vgpr 256
  .amdhsa_next_free_sgpr 100
  .amdhsa_accum_offset 256
  .amdhsa_group_segment_fixed_size 0
  .amdhsa_kernarg_size 96
  .amdhsa_user_sgpr_count 2
  .amdhsa_user_sgpr_kernarg_segment_ptr 1
  .amdhsa_system_sgpr_workgroup_id_x 1
.end_amdhsa_kernel
```
